```python
import torch

def _softmax(x, axis=-1):
    return torch.softmax(x, dim=axis)

def _gelu(x):
    return torch.nn.functional.gelu(x, approximate='tanh')

def _silu(x):
    return torch.nn.functional.silu(x)

def _sigmoid(x):
    return torch.sigmoid(x)

def _layernorm(x, axis=-1, eps=1e-05):
    m = x.mean(dim=axis, keepdim=True)
    v = x.var(dim=axis, keepdim=True, unbiased=False)
    return (x - m) / torch.sqrt(v + eps)

def _scatter_add(tgt, idx, src, axis=0):
    return tgt.clone().index_add_(axis, idx, src)

def _segment_sum(src, seg, n):
    out = torch.zeros((n,) + src.shape[1:], dtype=src.dtype)
    return out.index_add_(0, seg, src)

def _pad(x, pw):
    flat = tuple((v for pair in reversed(pw) for v in pair))
    return torch.nn.functional.pad(x, flat)
kernel_name = 'standalone__window_attn_davit__vision'

def setup_inputs():

    _w = lambda a: (lambda t: t.to(torch.bfloat16) if t.is_floating_point() else t)(torch.as_tensor(a))
    HW = 224
    C0 = 192
    ws = 7
    nh = 4
    H = W = max(HW // ws * ws, ws)
    C = max(C0 // nh * nh, nh)
    k = 3
    return {'x': _w((lambda *s: torch.randn(*s, dtype=torch.bfloat16) * 1.6)(1, H, W, C)), 'dw_pe': _w((lambda *s: torch.randn(*s, dtype=torch.bfloat16) * 1.6)(k, k, C) * 0.1), 'w_qkv': _w((lambda *s: torch.randn(*s, dtype=torch.bfloat16) * 1.6)(C, 3 * C) * C ** (-0.5)), 'w_o': _w((lambda *s: torch.randn(*s, dtype=torch.bfloat16) * 0.4)(C, C) * C ** (-0.5))}

def reference(x, dw_pe, w_qkv, w_o):
    B, H, W, C = x.shape
    ws = 7
    nh = 4
    dh = C // nh
    kk = dw_pe.shape[0]
    pad = kk // 2
    xp = _pad(x, ((0, 0), (pad, pad), (pad, pad), (0, 0)))
    pe = torch.zeros_like(x)
    for i in range(kk):
        for j in range(kk):
            pe = pe + xp[:, i:i + H, j:j + W, :] * dw_pe[i, j][None, None, None, :]
    x0 = x + pe
    h = _layernorm(x0, axis=-1)
    hw = h.reshape(B, H // ws, ws, W // ws, ws, C)
    hw = (lambda x, *d: x.permute(*d))(hw, 0, 1, 3, 2, 4, 5)
    hw = hw.reshape(-1, ws * ws, C)
    qkv = (hw @ w_qkv).reshape(-1, ws * ws, 3, nh, dh)
    q = qkv[:, :, 0].clone()
    k = qkv[:, :, 1].clone()
    v = qkv[:, :, 2].clone()
    scale = dh ** (-0.5)
    attn = torch.einsum('wnhd,wmhd->whnm', q, k) * scale
    attn = _softmax(attn, axis=-1)
    out = torch.einsum('whnm,wmhd->wnhd', attn, v)
    out = out.reshape(-1, ws * ws, C) @ w_o
    out = out.reshape(B, H // ws, W // ws, ws, ws, C)
    out = (lambda x, *d: x.permute(*d))(out, 0, 1, 3, 2, 4, 5)
    out = out.reshape(B, H, W, C)
    return x0 + out
```

```asm
; @launch grid=(256,1,1) block=(256,1,1) lds=163840
.amdgcn_target "amdgcn-amd-amdhsa--gfx950"
.text
.globl standalone__window_attn_davit__vision_kernel
.p2align 8
.type standalone__window_attn_davit__vision_kernel,@function
standalone__window_attn_davit__vision_kernel:

    s_load_dwordx2 s[16:17], s[0:1], 0
    s_load_dwordx2 s[20:21], s[0:1], 8
    s_load_dwordx2 s[24:25], s[0:1], 16
    s_load_dwordx2 s[28:29], s[0:1], 24
    s_load_dwordx2 s[32:33], s[0:1], 32
    s_cmp_ge_u32 s2, 256
    s_cbranch_scc1 L_end
    s_lshr_b32 s38, s2, 3
    s_getpc_b64 s[88:89]
L_pc:
    v_lshrrev_b32 v4, 4, v0
    v_lshlrev_b32 v4, 7, v4
    v_lshl_add_u32 v4, s38, 11, v4
    v_min_u32 v4, L_end-L_pc, v4
    v_mov_b32 v5, s89
    v_add_co_u32 v4, vcc, s88, v4
    v_and_b32 v1, 63, v0
    v_lshrrev_b32 v6, 6, v0
    v_addc_co_u32 v5, vcc, 0, v5, vcc
    global_load_dword v15, v[4:5], off
    v_readfirstlane_b32 s36, v6
    s_and_b32 s37, s2, 7
    s_mov_b32 s18, 19267584
    s_mov_b32 s19, 0x20000
    s_mul_i32 s41, s36, 60
    s_min_u32 s41, s41, 170
    s_mul_i32 s42, s38, 7
    s_sub_u32 s42, s42, 1
    v_add_u32 v6, s41, v1
    v_mul_u32_u24 v8, 2521, v6
    v_lshrrev_b32 v8, 16, v8
    v_mul_u32_u24 v9, 26, v8
    v_sub_u32 v9, v6, v9
    v_add_u32 v5, s42, v8
    v_cmp_gt_u32 s[76:77], 24, v9
    v_cmp_gt_u32 vcc, 224, v5
    v_mul_u32_u24 v5, 384, v5
    v_lshl_add_u32 v5, v9, 4, v5
    s_and_b64 vcc, vcc, s[76:77]
    v_bfrev_b32 v7, 2
    s_lshl_b32 s40, s41, 4
    v_cndmask_b32 v252, v7, v5, vcc
    s_mul_i32 s39, s37, 2408448
    s_mov_b32 s91, 86016
    s_movk_i32 s90, 3744
    s_sub_u32 s68, s39, s91
    s_cselect_b32 s68, 0x40000000, s68
    s_add_u32 s69, s39, 602112
    v_mul_u32_u24 v4, 43, v1
    v_lshrrev_b32 v4, 8, v4
    v_mul_u32_u24 v5, 288, v4
    v_lshl_add_u32 v12, v1, 4, v5
    s_movk_i32 s22, 3456
    s_mov_b32 s23, s19
    s_mul_i32 s43, s36, 96
    s_lshl_b32 s86, s36, 10
    s_add_u32 s86, s86, 65536
    s_mov_b32 m0, s86
    s_waitcnt lgkmcnt(0)
    buffer_load_dwordx4 v12, s[20:23], s43 offen lds
    s_add_u32 m0, s40, 29952
    s_nop 0
    buffer_load_dwordx4 v252, s[16:19], s69 offen nt lds
    s_sub_u32 m0, m0, s90
    s_sub_u32 s69, s69, s91
    buffer_load_dwordx4 v252, s[16:19], s69 offen nt lds
    s_sub_u32 m0, m0, s90
    s_sub_u32 s69, s69, s91
    buffer_load_dwordx4 v252, s[16:19], s69 offen nt lds
    s_sub_u32 m0, m0, s90
    s_sub_u32 s69, s69, s91
    buffer_load_dwordx4 v252, s[16:19], s69 offen nt lds
    s_sub_u32 m0, m0, s90
    s_sub_u32 s69, s69, s91
    buffer_load_dwordx4 v252, s[16:19], s69 offen nt lds
    s_sub_u32 m0, m0, s90
    s_sub_u32 s69, s69, s91
    buffer_load_dwordx4 v252, s[16:19], s69 offen nt lds
    s_sub_u32 m0, m0, s90
    s_sub_u32 s69, s69, s91
    buffer_load_dwordx4 v252, s[16:19], s69 offen nt lds
    s_sub_u32 m0, m0, s90
    s_sub_u32 s69, s69, s91
    buffer_load_dwordx4 v252, s[16:19], s69 offen nt lds
    s_sub_u32 m0, m0, s90
    s_nop 0
    buffer_load_dwordx4 v252, s[16:19], s68 offen nt lds
    s_mov_b32 s26, 221184
    s_mov_b32 s27, s19
    s_mov_b32 s30, 73728
    s_mov_b32 s31, s19
    v_lshrrev_b32 v16, 2, v0
    v_lshlrev_b32 v16, 7, v16
    s_lshl_b32 s85, s38, 13
    v_mul_u32_u24 v4, 86, v8
    v_lshrrev_b32 v4, 8, v4
    v_mul_u32_u24 v5, 3, v4
    v_sub_u32 v5, v8, v5
    v_add_u32 v5, s42, v5
    v_cmp_le_i32 vcc, 0, v5
    v_mul_u32_u24 v4, 602112, v4
    v_mul_u32_u24 v5, 384, v5
    buffer_load_dword v18, v16, s[24:27], s85 offen
    s_xor_b32 s85, s85, 253952
    s_and_b64 vcc, vcc, s[76:77]
    v_lshl_add_u32 v5, v9, 4, v5
    v_add_u32 v5, v5, v4
    v_cndmask_b32 v11, v7, v5, vcc
    s_add_u32 m0, s40, 108544
    s_add_u32 s69, s39, 1032192
    s_add_u32 s70, s39, 688128
    s_add_u32 s71, s39, 774144
    s_add_u32 s68, s39, 860160
    v_and_b32 v2, 15, v1
    v_lshrrev_b32 v3, 4, v1
    v_lshrrev_b32 v10, 5, v1
    v_lshl_add_u32 v12, v2, 1, s86
    v_add_u32 v13, v3, v10
    v_mul_u32_u24 v13, 96, v13
    v_add_u32 v13, v13, v12
    v_lshlrev_b32 v14, 2, v3
    s_mov_b32 s87, 0x8276
    v_bfe_u32 v14, s87, v14, 4
    v_mul_u32_u24 v14, 96, v14
    v_add_u32 v14, v14, v12
    v_and_b32 v4, 16, v1
    v_add_u32 v20, s43, v4
    v_add_u32 v25, 4, v2
    v_bfe_u32 v21, v25, 3, 1
    v_and_b32 v27, 7, v25
    v_mul_u32_u24 v22, 416, v10
    v_mul_u32_u24 v23, 7488, v10
    s_mov_b32 s58, 0x08080808
    s_mov_b32 s59, s58
    v_add_u32 v5, 1, v21
    v_cndmask_b32 v27, v27, v5, s[58:59]
    v_cndmask_b32 v26, v21, 6, s[58:59]
    v_mad_u32_u24 v6, v26, 9, v27
    v_mul_u32_u24 v6, 416, v6
    v_add3_u32 v236, v6, v20, v22
    v_add3_u32 v239, v6, v20, v23
    v_cndmask_b32 v6, 18, 2, s[58:59]
    v_mul_u32_u24 v6, 416, v6
    v_add_u32 v237, v236, v6
    v_add_u32 v240, v239, v6
    v_add_u32 v238, v237, v6
    v_add_u32 v241, v240, v6
    v_and_b32 v4, 3, v1
    v_mul_u32_u24 v255, 0x5555, v4
    v_lshlrev_b32 v24, 4, v1
    v_and_b32 v24, 16, v24
    s_mov_b32 vcc_lo, 0x03000003
    s_mov_b32 vcc_hi, vcc_lo
    v_add_u32 v5, 0, v1
    v_mul_u32_u24 v6, 43691, v5
    v_lshrrev_b32 v6, 18, v6
    v_mul_u32_u24 v7, 6, v6
    v_sub_u32 v5, v5, v7
    v_lshlrev_b32 v5, 4, v5
    v_mul_u32_u24 v7, 1152, v6
    v_add_u32 v28, v5, v7
    v_mul_u32_u24 v7, 384, v6
    v_add_u32 v32, v5, v7
    v_add_u32 v5, 64, v1
    v_mul_u32_u24 v6, 43691, v5
    v_lshrrev_b32 v6, 18, v6
    v_mul_u32_u24 v7, 6, v6
    v_sub_u32 v5, v5, v7
    v_lshlrev_b32 v5, 4, v5
    v_subrev_u32 v5, 1024, v5
    v_mul_u32_u24 v7, 1152, v6
    v_add_u32 v29, v5, v7
    v_add_u32 v7, 36864, v29
    s_mul_i32 s92, s36, 3072
    s_mov_b32 s52, 0x22222222
    s_mov_b32 s53, s52
    s_mov_b32 s54, 0x44444444
    s_mov_b32 s55, s54
    s_mov_b32 s56, 0x88888888
    s_mov_b32 s57, s56
    v_mov_b32 v228, 0x3f803f80
    v_mov_b32 v229, v228
    v_mov_b32 v230, v228
    v_mov_b32 v231, v228
    v_lshlrev_b32 v4, 4, v1
    v_add_u32 v247, 64512, v4
    s_lshl_b32 s41, s36, 10
    v_add_u32 v245, s41, v247
    s_add_u32 s77, s41, 83968
    v_lshl_add_u32 v248, v2, 4, s77
    s_lshr_b32 s41, s36, 1
    s_and_b32 s42, s36, 1
    s_lshl_b32 s42, s42, 3
    s_lshl_b32 s76, s41, 10
    s_add_u32 s76, s76, s42
    s_add_u32 s84, s76, 88064
    s_add_u32 s76, s76, 4096
    v_add_u32 v246, s76, v247
    s_mov_b32 s45, 0x3baaaaab
    s_mov_b32 s46, 0x3727c5ac
    v_and_b32 v4, 3, v1
    s_lshl_b32 s76, s36, 8
    s_add_u32 s41, s41, 4
    buffer_load_dword v19, v16, s[28:31], s85 offen
    s_waitcnt vmcnt(11)
    ds_read_u16 v139, v12 offset:480
    ds_read_u16 v151, v12 offset:512
    ds_read_u16 v163, v12 offset:544
    ds_read_u16 v143, v13 offset:0
    ds_read_u16 v155, v13 offset:32
    ds_read_u16 v167, v13 offset:64
    ds_read_u16 v147, v14 offset:0
    ds_read_u16 v159, v14 offset:32
    ds_read_u16 v171, v14 offset:64
    s_mov_b32 exec_hi, 0
    s_waitcnt lgkmcnt(7)
    v_mov_b32 v139, 0x3f80
    v_mov_b32 v151, 0x3f80
    s_waitcnt lgkmcnt(6)
    v_mov_b32 v163, 0x3f80
    s_mov_b32 exec_hi, -1
    buffer_load_dwordx4 v11, s[16:19], s69 offen nt lds
    s_add_u32 m0, m0, s90
    s_add_u32 s69, s69, s91
    v_lshlrev_b32 v139, v24, v139
    v_lshlrev_b32 v151, v24, v151
    v_lshlrev_b32 v163, v24, v163
    v_cndmask_b32 v136, 0, v139, vcc
    v_cndmask_b32 v148, 0, v151, vcc
    v_cndmask_b32 v160, 0, v163, vcc
    s_lshl_b64 vcc, vcc, 2
    v_cndmask_b32 v137, 0, v139, vcc
    v_cndmask_b32 v149, 0, v151, vcc
    v_cndmask_b32 v161, 0, v163, vcc
    s_lshl_b64 vcc, vcc, 2
    v_cndmask_b32 v138, 0, v139, vcc
    v_cndmask_b32 v150, 0, v151, vcc
    v_cndmask_b32 v162, 0, v163, vcc
    s_lshl_b64 vcc, vcc, 2
    v_cndmask_b32 v139, 0, v139, vcc
    v_cndmask_b32 v151, 0, v151, vcc
    v_cndmask_b32 v163, 0, v163, vcc
    s_mov_b32 vcc_lo, 0x000f000f
    buffer_load_dwordx4 v11, s[16:19], s69 offen nt lds
    s_add_u32 m0, m0, s90
    s_add_u32 s69, s69, s91
    s_mov_b32 vcc_hi, vcc_lo
    s_waitcnt lgkmcnt(0)
    v_cndmask_b32 v140, 0, v143, vcc
    v_cndmask_b32 v152, 0, v155, vcc
    v_cndmask_b32 v164, 0, v167, vcc
    v_cndmask_b32 v144, 0, v147, vcc
    v_cndmask_b32 v156, 0, v159, vcc
    v_cndmask_b32 v168, 0, v171, vcc
    s_lshl_b64 vcc, vcc, 4
    v_cndmask_b32 v141, 0, v143, vcc
    v_cndmask_b32 v153, 0, v155, vcc
    v_cndmask_b32 v165, 0, v167, vcc
    v_cndmask_b32 v145, 0, v147, vcc
    v_cndmask_b32 v157, 0, v159, vcc
    v_cndmask_b32 v169, 0, v171, vcc
    s_lshl_b64 vcc, vcc, 4
    v_cndmask_b32 v142, 0, v143, vcc
    v_cndmask_b32 v154, 0, v155, vcc
    v_cndmask_b32 v166, 0, v167, vcc
    v_cndmask_b32 v146, 0, v147, vcc
    v_cndmask_b32 v158, 0, v159, vcc
    v_cndmask_b32 v170, 0, v171, vcc
    s_lshl_b64 vcc, vcc, 4
    v_cndmask_b32 v143, 0, v143, vcc
    buffer_load_dwordx4 v11, s[16:19], s69 offen nt lds
    s_add_u32 m0, s40, 33696
    s_add_u32 s69, s39, 946176
    v_cndmask_b32 v155, 0, v155, vcc
    v_cndmask_b32 v167, 0, v167, vcc
    v_cndmask_b32 v147, 0, v147, vcc
    v_cndmask_b32 v159, 0, v159, vcc
    v_cndmask_b32 v171, 0, v171, vcc
    v_cmp_lt_u32 vcc, 15, v6
    s_mov_b32 s34, 19267584
    s_mov_b32 s35, 0x20000
    v_cndmask_b32 v31, v29, v7, vcc
    v_mul_u32_u24 v7, 384, v6
    v_add_u32 v33, v5, v7
    v_add_u32 v7, 12288, v33
    v_cndmask_b32 v35, v33, v7, vcc
    v_add_u32 v5, 128, v1
    v_mul_u32_u24 v6, 43691, v5
    v_lshrrev_b32 v6, 18, v6
    v_mul_u32_u24 v7, 6, v6
    v_sub_u32 v5, v5, v7
    v_lshlrev_b32 v5, 4, v5
    v_subrev_u32 v5, 2048, v5
    v_mul_u32_u24 v7, 1152, v6
    v_add_u32 v30, v5, v7
    v_mul_u32_u24 v7, 384, v6
    buffer_load_dwordx4 v252, s[16:19], s70 offen nt lds
    s_add_u32 m0, s40, 37440
    s_add_u32 s70, s39, 1032192
    v_add_u32 v34, v5, v7
    v_lshrrev_b32 v5, 2, v1
    v_mul_u32_u24 v5, 96, v5
    v_and_b32 v6, 3, v1
    v_lshl_add_u32 v5, v6, 3, v5
    v_add_u32 v36, s92, v5
    v_add_u32 v37, 90112, v36
    v_lshl_add_u32 v5, v2, 4, s84
    v_lshrrev_b32 v6, 2, v2
    v_cmp_eq_u32 vcc, v6, v3
    v_add_u32 v6, 8, v248
    v_mov_b32 v7, 22464
    v_cndmask_b32 v249, v6, v5, vcc
    v_mul_u32_u24 v6, 1248, v4
    v_add_u32 v6, 107296, v6
    v_cmp_eq_u32 vcc, 0, v4
    v_lshl_add_u32 v5, v3, 2, v4
    v_lshlrev_b32 v5, 4, v5
    v_cndmask_b32 v6, v6, v7, vcc
    v_add3_u32 v16, v6, v20, v22
    v_add3_u32 v17, v6, v20, v23
    v_add_u32 v38, 59904, v5
    buffer_load_dwordx4 v252, s[16:19], s71 offen nt lds
    s_add_u32 m0, s40, 41184
    s_add_u32 s71, s39, 1118208
    v_add_u32 v250, s76, v38
    s_lshl_b32 s76, s41, 8
    s_add_u32 s76, s76, s42
    v_add_u32 v251, s76, v38
    s_mov_b32 s44, 0x3e553b95
    s_mov_b32 s60, 0x11111111
    s_mov_b32 s61, 0x11111111
    s_mov_b32 s62, 0x22222222
    s_mov_b32 s63, 0x22222222
    s_mov_b32 s64, 0x44444444
    s_mov_b32 s65, 0x44444444
    s_mov_b32 s66, 0x88888888
    s_mov_b32 s67, 0x88888888
    v_cmp_gt_u32 vcc, 16, v1
    v_mov_b32 v6, 0x3f80
    v_lshlrev_b32 v6, v24, v6
    v_cndmask_b32 v232, 0, v228, vcc
    v_mov_b32 v233, v232
    s_mov_b32 vcc_lo, 0x00300003
    s_mov_b32 vcc_hi, 0x30000300
    v_cndmask_b32 v234, 0, v6, vcc
    s_lshl_b64 vcc, vcc, 2
    v_cndmask_b32 v235, 0, v6, vcc
    buffer_load_dwordx4 v252, s[16:19], s68 offen nt lds
    s_add_u32 m0, s40, 44928
    s_add_u32 s68, s39, 1204224
    s_add_u32 s41, s43, 126976
    v_lshl_add_u32 v4, v3, 3, s41
    v_mad_u32_u24 v6, v26, 7, v27
    v_mul_u32_u24 v6, 400, v6
    v_add_u32 v242, v6, v4
    v_cndmask_b32 v6, 14, 2, s[58:59]
    v_mul_u32_u24 v6, 400, v6
    v_add_u32 v243, v242, v6
    v_add_u32 v244, v243, v6
    s_mul_i32 s41, s36, 40
    v_add_u32 v4, s41, v1
    v_min_u32 v5, 167, v4
    v_mul_u32_u24 v6, 2731, v5
    v_lshrrev_b32 v6, 16, v6
    v_add_u32 v6, v6, v5
    v_lshlrev_b32 v6, 4, v6
    v_add_u32 v253, 126976, v6
    s_mul_i32 s42, s38, 2688
    v_lshl_add_u32 v5, v4, 4, s42
    s_add_u32 s41, s36, 1
    s_and_b32 s41, s41, 4
    s_lshl_b32 s41, s41, 1
    s_add_u32 s41, s41, 40
    buffer_load_dwordx4 v252, s[16:19], s69 offen nt lds
    s_add_u32 m0, s40, 48672
    s_add_u32 s69, s43, 384
    v_bfrev_b32 v7, 2
    v_cmp_gt_u32 vcc, s41, v1
    v_cmp_lt_u32 s[48:49], 23, v4
    s_nop 0
    v_cndmask_b32 v254, v7, v5, vcc
    buffer_load_dwordx4 v252, s[16:19], s70 offen nt lds
    s_add_u32 m0, s40, 52416
    s_add_u32 s70, s43, 55680
    buffer_load_dwordx4 v252, s[16:19], s71 offen nt lds
    s_add_u32 m0, s40, 56160
    s_add_u32 s71, s43, 110976
    s_waitcnt vmcnt(11)
    s_barrier
    ds_read_b128 v[20:23], v236 offset:4160
    ds_read_b128 v[24:27], v236 offset:4192
    ds_read_b128 v[40:43], v236 offset:4224
    ds_read_b128 v[48:51], v236 offset:0
    ds_read_b128 v[52:55], v236 offset:3744
    ds_read_b128 v[56:59], v236 offset:32
    ds_read_b128 v[60:63], v236 offset:3776
    buffer_load_dwordx4 v252, s[16:19], s68 offen nt lds
    ds_read_b128 v[64:67], v236 offset:64
    ds_read_b128 v[68:71], v236 offset:3808
    ds_read_b128 v[72:75], v236 offset:7488
    ds_read_b128 v[76:79], v239 offset:832
    s_add_u32 m0, s92, 126976
    ds_read_b128 v[80:83], v236 offset:7520
    s_add_u32 s68, s43, 166272
    ds_read_b128 v[84:87], v239 offset:864
    ds_read_b128 v[88:91], v236 offset:7552
    s_waitcnt lgkmcnt(13)
    v_mfma_f32_16x16x32_bf16 v[44:47], v[136:139], v[20:23], 0
    buffer_load_dwordx4 v28, s[24:27], s69 offen lds
    s_waitcnt lgkmcnt(12)
    v_mfma_f32_16x16x32_bf16 v[20:23], v[148:151], v[24:27], 0
    ds_read_b128 v[92:95], v239 offset:896
    s_waitcnt lgkmcnt(12)
    v_mfma_f32_16x16x32_bf16 v[24:27], v[160:163], v[40:43], 0
    ds_read_b128 v[40:43], v237 offset:4160
    ds_read_b128 v[96:99], v237 offset:4192
    ds_read_b128 v[100:103], v237 offset:4224
    s_waitcnt lgkmcnt(13)
    v_smfmac_f32_16x16x64_bf16 v[44:47], v[140:143], v[48:55], v255
    ds_read_b128 v[104:107], v237 offset:0
    ds_read_b128 v[108:111], v237 offset:3744
    s_waitcnt lgkmcnt(13)
    v_smfmac_f32_16x16x64_bf16 v[20:23], v[152:155], v[56:63], v255
    ds_read_b128 v[112:115], v237 offset:32
    ds_read_b128 v[116:119], v237 offset:3776
    s_waitcnt lgkmcnt(13)
    v_smfmac_f32_16x16x64_bf16 v[24:27], v[164:167], v[64:71], v255
    ds_read_b128 v[120:123], v237 offset:64
    ds_read_b128 v[124:127], v237 offset:3808
    s_waitcnt lgkmcnt(13)
    v_smfmac_f32_16x16x64_bf16 v[44:47], v[144:147], v[72:79], v255
    ds_read_b128 v[128:131], v237 offset:7488
    ds_read_b128 v[132:135], v240 offset:832
    s_waitcnt lgkmcnt(13)
    v_smfmac_f32_16x16x64_bf16 v[20:23], v[156:159], v[80:87], v255
    ds_read_b128 v[8:11], v237 offset:7520
    ds_read_b128 v[12:15], v240 offset:864
    s_waitcnt lgkmcnt(13)
    v_smfmac_f32_16x16x64_bf16 v[24:27], v[168:171], v[88:95], v255
    ds_read_b128 v[0:3], v237 offset:7552
    s_waitcnt lgkmcnt(13)
    v_mfma_f32_16x16x32_bf16 v[48:51], v[136:139], v[40:43], 0
    ds_read_b128 v[4:7], v240 offset:896
    s_waitcnt lgkmcnt(13)
    v_mfma_f32_16x16x32_bf16 v[52:55], v[148:151], v[96:99], 0
    ds_read_b128 v[40:43], v238 offset:4160
    s_waitcnt lgkmcnt(13)
    v_mfma_f32_16x16x32_bf16 v[96:99], v[160:163], v[100:103], 0
    ds_read_b128 v[100:103], v238 offset:4192
    v_cvt_pk_bf16_f32 v56, v44, v45
    v_cvt_pk_bf16_f32 v57, v46, v47
    v_cvt_pk_bf16_f32 v58, v20, v21
    s_waitcnt lgkmcnt(12)
    v_smfmac_f32_16x16x64_bf16 v[48:51], v[140:143], v[104:111], v255
    ds_read_b128 v[60:63], v238 offset:4224
    ds_read_b128 v[64:67], v238 offset:0
    v_cvt_pk_bf16_f32 v59, v22, v23
    v_cvt_pk_bf16_f32 v76, v24, v25
    s_waitcnt lgkmcnt(12)
    v_smfmac_f32_16x16x64_bf16 v[52:55], v[152:155], v[112:119], v255
    ds_read_b128 v[68:71], v238 offset:3744
    v_mfma_f32_16x16x32_bf16 v[72:75], v[56:59], v[56:59], 0
    ds_read_b128 v[80:83], v238 offset:32
    ds_read_b128 v[84:87], v238 offset:3776
    v_mfma_f32_16x16x32_bf16 v[88:91], v[228:231], v[56:59], 0
    s_waitcnt lgkmcnt(14)
    ds_read_b128 v[104:107], v238 offset:64
    s_waitcnt lgkmcnt(14)
    v_smfmac_f32_16x16x64_bf16 v[96:99], v[164:167], v[120:127], v255
    ds_read_b128 v[108:111], v238 offset:3808
    s_waitcnt lgkmcnt(13)
    v_smfmac_f32_16x16x64_bf16 v[48:51], v[144:147], v[128:135], v255
    ds_read_b128 v[112:115], v238 offset:7488
    v_cvt_pk_bf16_f32 v77, v26, v27
    ds_read_b128 v[116:119], v241 offset:832
    s_waitcnt lgkmcnt(13)
    v_smfmac_f32_16x16x64_bf16 v[52:55], v[156:159], v[8:15], v255
    ds_read_b128 v[120:123], v238 offset:7520
    v_mfma_f32_16x16x16_bf16 v[72:75], v[76:77], v[76:77], v[72:75]
    s_waitcnt lgkmcnt(13)
    ds_read_b128 v[124:127], v241 offset:864
    v_cvt_pk_bf16_f32 v92, v48, v49
    v_mfma_f32_16x16x16_bf16 v[88:91], v[228:229], v[76:77], v[88:91]
    s_waitcnt lgkmcnt(13)
    ds_read_b128 v[128:131], v238 offset:7552
    v_cvt_pk_bf16_f32 v93, v50, v51
    v_smfmac_f32_16x16x64_bf16 v[96:99], v[168:171], v[0:7], v255
    s_waitcnt lgkmcnt(13)
    ds_read_b128 v[132:135], v241 offset:896
    v_mfma_f32_16x16x32_bf16 v[8:11], v[136:139], v[40:43], 0
    s_waitcnt lgkmcnt(13)
    v_cndmask_b32 v72, v72, v73, s[52:53]
    v_cndmask_b32 v72, v72, v74, s[54:55]
    v_mfma_f32_16x16x32_bf16 v[12:15], v[148:151], v[100:103], 0
    s_waitcnt lgkmcnt(12)
    v_cndmask_b32 v89, v72, v75, s[56:57]
    v_cvt_pk_bf16_f32 v94, v52, v53
    v_mfma_f32_16x16x32_bf16 v[40:43], v[160:163], v[60:63], 0
    s_waitcnt lgkmcnt(11)
    ds_write_b64 v249, v[88:89] offset:0
    s_waitcnt lgkmcnt(11)
    v_smfmac_f32_16x16x64_bf16 v[8:11], v[140:143], v[64:71], v255
    s_waitcnt lgkmcnt(10)
    s_waitcnt lgkmcnt(9)
    v_smfmac_f32_16x16x64_bf16 v[12:15], v[152:155], v[80:87], v255
    v_cvt_pk_bf16_f32 v95, v54, v55
    v_cvt_pk_bf16_f32 v78, v96, v97
    v_cvt_pk_bf16_f32 v79, v98, v99
    v_mfma_f32_16x16x32_bf16 v[100:103], v[92:95], v[92:95], 0
    s_waitcnt lgkmcnt(8)
    v_mfma_f32_16x16x32_bf16 v[72:75], v[228:231], v[92:95], 0
    s_waitcnt lgkmcnt(7)
    v_smfmac_f32_16x16x64_bf16 v[40:43], v[164:167], v[104:111], v255
    s_waitcnt lgkmcnt(6)
    s_waitcnt lgkmcnt(5)
    v_smfmac_f32_16x16x64_bf16 v[8:11], v[144:147], v[112:119], v255
    v_mfma_f32_16x16x16_bf16 v[100:103], v[78:79], v[78:79], v[100:103]
    s_waitcnt lgkmcnt(4)
    v_mfma_f32_16x16x16_bf16 v[72:75], v[228:229], v[78:79], v[72:75]
    s_waitcnt lgkmcnt(3)
    v_smfmac_f32_16x16x64_bf16 v[12:15], v[156:159], v[120:127], v255
    s_waitcnt lgkmcnt(2)
    s_waitcnt lgkmcnt(1)
    v_smfmac_f32_16x16x64_bf16 v[40:43], v[168:171], v[128:135], v255
    v_cvt_pk_bf16_f32 v60, v8, v9
    v_cndmask_b32 v100, v100, v101, s[52:53]
    v_cndmask_b32 v100, v100, v102, s[54:55]
    v_cndmask_b32 v73, v100, v103, s[56:57]
    ds_write_b64 v249, v[72:73] offset:256
    v_cvt_pk_bf16_f32 v61, v10, v11
    v_cvt_pk_bf16_f32 v62, v12, v13
    v_cvt_pk_bf16_f32 v63, v14, v15
    v_cvt_pk_bf16_f32 v88, v40, v41
    v_cvt_pk_bf16_f32 v89, v42, v43
    v_mfma_f32_16x16x32_bf16 v[100:103], v[60:63], v[60:63], 0
    v_mfma_f32_16x16x32_bf16 v[72:75], v[228:231], v[60:63], 0
    buffer_load_dwordx4 v29, s[24:27], s69 offen offset:1024 lds
    s_nop 3
    v_mfma_f32_16x16x16_bf16 v[100:103], v[88:89], v[88:89], v[100:103]
    v_mfma_f32_16x16x16_bf16 v[72:75], v[228:229], v[88:89], v[72:75]
    s_nop 6
    v_cndmask_b32 v100, v100, v101, s[52:53]
    v_cndmask_b32 v100, v100, v102, s[54:55]
    v_cndmask_b32 v73, v100, v103, s[56:57]
    ds_write_b64 v249, v[72:73] offset:512
    buffer_load_dwordx4 v30, s[24:27], s69 offen offset:2048 lds
    s_add_u32 m0, s92, 139264
    s_add_u32 s69, s43, 37248
    buffer_load_dwordx4 v28, s[24:27], s70 offen lds
    s_waitcnt vmcnt(11) lgkmcnt(0)
    s_barrier
    ds_read_b128 v[100:103], v247 offset:23552
    ds_read_b128 v[72:75], v247 offset:24576
    ds_read_b128 v[0:3], v16 offset:4160
    ds_read_b128 v[4:7], v16 offset:4192
    ds_read_b128 v[64:67], v16 offset:4224
    ds_read_b128 v[80:83], v16 offset:0
    ds_read_b128 v[84:87], v16 offset:3744
    ds_read_b128 v[104:107], v16 offset:32
    ds_read_b128 v[108:111], v16 offset:3776
    ds_read_b128 v[112:115], v16 offset:64
    ds_read_b128 v[116:119], v16 offset:3808
    ds_read_b128 v[120:123], v16 offset:7488
    ds_read_b128 v[124:127], v17 offset:832
    s_waitcnt lgkmcnt(12)
    v_add_f32 v100, v100, v102
    v_add_f32 v101, v101, v103
    ds_read_b128 v[128:131], v16 offset:7520
    s_waitcnt lgkmcnt(12)
    v_add_f32 v72, v72, v74
    v_add_f32 v73, v73, v75
    s_waitcnt lgkmcnt(11)
    v_mfma_f32_16x16x32_bf16 v[68:71], v[136:139], v[0:3], 0
    ds_read_b128 v[132:135], v17 offset:864
    s_waitcnt lgkmcnt(11)
    v_mfma_f32_16x16x32_bf16 v[0:3], v[148:151], v[4:7], 0
    s_waitcnt lgkmcnt(10)
    v_add_f32 v100, v100, v72
    v_mfma_f32_16x16x32_bf16 v[4:7], v[160:163], v[64:67], 0
    v_add_f32 v101, v101, v73
    v_mul_f32 v102, s45, v100
    v_mul_f32 v101, s45, v101
    v_fma_f32 v101, -v102, v102, v101
    v_max_f32 v101, 0, v101
    v_add_f32 v101, s46, v101
    s_waitcnt lgkmcnt(8)
    v_smfmac_f32_16x16x64_bf16 v[68:71], v[140:143], v[80:87], v255
    buffer_load_dwordx4 v29, s[24:27], s70 offen offset:1024 lds
    ds_read_b128 v[80:83], v16 offset:7552
    ds_read_b128 v[84:87], v17 offset:896
    s_waitcnt lgkmcnt(8)
    v_smfmac_f32_16x16x64_bf16 v[0:3], v[152:155], v[104:111], v255
    v_rsq_f32 v100, v101
    s_waitcnt lgkmcnt(6)
    v_smfmac_f32_16x16x64_bf16 v[4:7], v[164:167], v[112:119], v255
    v_mul_f32 v101, -v102, v100
    ds_write_b64 v245, v[100:101] offset:19456
    s_waitcnt lgkmcnt(5)
    v_smfmac_f32_16x16x64_bf16 v[68:71], v[144:147], v[120:127], v255
    buffer_load_dwordx4 v30, s[24:27], s70 offen offset:2048 lds
    s_waitcnt lgkmcnt(3)
    v_smfmac_f32_16x16x64_bf16 v[0:3], v[156:159], v[128:135], v255
    s_add_u32 m0, s92, 151552
    s_add_u32 s70, s43, 74112
    ds_read_b64 v[72:73], v248 offset:0
    ds_read_b64 v[74:75], v248 offset:256
    ds_read_b64 v[102:103], v248 offset:512
    v_cvt_pk_bf16_f32 v64, v68, v69
    v_cvt_pk_bf16_f32 v65, v70, v71
    s_waitcnt lgkmcnt(4)
    v_smfmac_f32_16x16x64_bf16 v[4:7], v[168:171], v[80:87], v255
    v_cvt_pk_bf16_f32 v66, v0, v1
    v_cvt_pk_bf16_f32 v67, v2, v3
    ds_write_b128 v250, v[64:67] offset:3072
    s_waitcnt lgkmcnt(3)
    v_fma_f32 v44, v44, v72, v73
    v_mfma_f32_16x16x32_bf16 v[16:19], v[64:67], v[64:67], 0
    v_fma_f32 v45, v45, v72, v73
    v_fma_f32 v46, v46, v72, v73
    v_mfma_f32_16x16x32_bf16 v[104:107], v[228:231], v[64:67], 0
    s_waitcnt lgkmcnt(1)
    v_fma_f32 v47, v47, v72, v73
    v_fma_f32 v20, v20, v72, v73
    v_fma_f32 v21, v21, v72, v73
    v_fma_f32 v22, v22, v72, v73
    v_fma_f32 v23, v23, v72, v73
    v_fma_f32 v24, v24, v72, v73
    v_fma_f32 v25, v25, v72, v73
    v_fma_f32 v26, v26, v72, v73
    v_fma_f32 v27, v27, v72, v73
    v_cvt_pk_bf16_f32 v44, v44, v45
    v_cvt_pk_bf16_f32 v45, v46, v47
    v_cvt_pk_bf16_f32 v46, v20, v21
    v_cvt_pk_bf16_f32 v47, v22, v23
    v_cvt_pk_bf16_f32 v24, v24, v25
    v_cvt_pk_bf16_f32 v25, v26, v27
    ds_write_b128 v245, v[44:47] offset:1024
    buffer_load_dwordx4 v28, s[24:27], s71 offen lds
    v_fma_f32 v48, v48, v74, v75
    v_fma_f32 v49, v49, v74, v75
    v_fma_f32 v50, v50, v74, v75
    v_fma_f32 v51, v51, v74, v75
    v_fma_f32 v52, v52, v74, v75
    v_fma_f32 v53, v53, v74, v75
    v_fma_f32 v54, v54, v74, v75
    v_fma_f32 v55, v55, v74, v75
    v_fma_f32 v96, v96, v74, v75
    ds_write_b64 v246, v[24:25] offset:1024
    v_fma_f32 v97, v97, v74, v75
    v_fma_f32 v98, v98, v74, v75
    v_fma_f32 v99, v99, v74, v75
    v_cvt_pk_bf16_f32 v48, v48, v49
    v_cvt_pk_bf16_f32 v49, v50, v51
    v_cvt_pk_bf16_f32 v50, v52, v53
    buffer_load_dwordx4 v29, s[24:27], s71 offen offset:1024 lds
    v_cvt_pk_bf16_f32 v51, v54, v55
    v_cvt_pk_bf16_f32 v96, v96, v97
    v_cvt_pk_bf16_f32 v97, v98, v99
    ds_write_b128 v245, v[48:51] offset:7168
    v_fma_f32 v8, v8, v102, v103
    v_fma_f32 v9, v9, v102, v103
    v_fma_f32 v10, v10, v102, v103
    v_fma_f32 v11, v11, v102, v103
    v_fma_f32 v12, v12, v102, v103
    buffer_load_dwordx4 v30, s[24:27], s71 offen offset:2048 lds
    s_add_u32 m0, s92, 90112
    s_add_u32 s71, s43, 147840
    s_waitcnt vmcnt(6)
    ds_read_b64_tr_b16 a[0:1], v37 offset:36864
    ds_read_b64_tr_b16 a[2:3], v37 offset:38400
    ds_read_b64_tr_b16 a[4:5], v37 offset:36896
    ds_read_b64_tr_b16 a[6:7], v37 offset:38432
    ds_read_b64_tr_b16 a[8:9], v37 offset:36928
    ds_read_b64_tr_b16 a[10:11], v37 offset:38464
    ds_write_b64 v246, v[96:97] offset:7168
    v_fma_f32 v13, v13, v102, v103
    v_fma_f32 v14, v14, v102, v103
    v_fma_f32 v15, v15, v102, v103
    buffer_load_dwordx4 v28, s[24:27], s68 offen lds
    v_fma_f32 v40, v40, v102, v103
    v_fma_f32 v41, v41, v102, v103
    v_fma_f32 v42, v42, v102, v103
    v_fma_f32 v43, v43, v102, v103
    v_cvt_pk_bf16_f32 v8, v8, v9
    v_cvt_pk_bf16_f32 v9, v10, v11
    v_cvt_pk_bf16_f32 v10, v12, v13
    v_cvt_pk_bf16_f32 v11, v14, v15
    v_cvt_pk_bf16_f32 v40, v40, v41
    v_cvt_pk_bf16_f32 v41, v42, v43
    ds_write_b128 v245, v[8:11] offset:13312
    buffer_load_dwordx4 v29, s[24:27], s68 offen offset:1024 lds
    v_cvt_pk_bf16_f32 v108, v4, v5
    v_cvt_pk_bf16_f32 v109, v6, v7
    s_nop 1
    v_mfma_f32_16x16x16_bf16 v[16:19], v[108:109], v[108:109], v[16:19]
    s_waitcnt vmcnt(7) lgkmcnt(1)
    ds_write_b64 v246, v[40:41] offset:13312
    v_mfma_f32_16x16x16_bf16 v[104:107], v[228:229], v[108:109], v[104:107]
    buffer_load_dwordx4 v30, s[24:27], s68 offen offset:2048 lds
    s_add_u32 m0, s92, 126976
    ds_write_b64 v251, v[108:109] offset:3072
    s_add_u32 s68, s43, 184704
    s_nop 0
    v_cndmask_b32 v16, v16, v17, s[52:53]
    v_cndmask_b32 v16, v16, v18, s[54:55]
    s_waitcnt vmcnt(6)
    ds_read_b64_tr_b16 a[12:13], v37 offset:49152
    ds_read_b64_tr_b16 a[14:15], v37 offset:50688
    ds_read_b64_tr_b16 a[16:17], v37 offset:49184
    ds_read_b64_tr_b16 a[18:19], v37 offset:50720
    ds_read_b64_tr_b16 a[20:21], v37 offset:49216
    buffer_load_dwordx4 v28, s[24:27], s69 offen lds
    ds_read_b64_tr_b16 a[22:23], v37 offset:50752
    v_cndmask_b32 v105, v16, v19, s[56:57]
    ds_write_b64 v249, v[104:105] offset:37632
    s_waitcnt lgkmcnt(7)
    s_barrier
    ds_read_b128 v[64:67], v236 offset:30368
    ds_read_b128 v[24:27], v236 offset:30400
    buffer_load_dwordx4 v31, s[24:27], s69 offen offset:1024 lds
    ds_read_b128 v[72:75], v236 offset:30432
    ds_read_b128 v[112:115], v236 offset:26208
    ds_read_b128 v[116:119], v236 offset:29952
    ds_read_b128 v[120:123], v236 offset:26240
    ds_read_b128 v[124:127], v236 offset:29984
    ds_read_b128 v[128:131], v236 offset:26272
    s_waitcnt lgkmcnt(11)
    ds_read_b128 v[132:135], v236 offset:30016
    ds_read_b128 v[80:83], v236 offset:33696
    ds_read_b128 v[84:87], v239 offset:27040
    s_add_u32 s69, s43, 0
    ds_read_b128 v[48:51], v236 offset:33728
    s_waitcnt lgkmcnt(12)
    ds_read_b128 v[52:55], v239 offset:27072
    s_waitcnt lgkmcnt(12)
    v_mfma_f32_16x16x32_bf16 v[20:23], v[136:139], v[64:67], 0
    ds_read_b128 v[96:99], v236 offset:33760
    s_waitcnt lgkmcnt(12)
    v_mfma_f32_16x16x32_bf16 v[16:19], v[148:151], v[24:27], 0
    ds_read_b128 v[100:103], v239 offset:27104
    s_waitcnt lgkmcnt(12)
    v_mfma_f32_16x16x32_bf16 v[64:67], v[160:163], v[72:75], 0
    ds_read_b128 v[24:27], v238 offset:30368
    buffer_load_dwordx4 v30, s[24:27], s70 offen offset:2048 lds
    s_add_u32 m0, s92, 108544
    ds_read_b128 v[72:75], v238 offset:30400
    s_add_u32 s70, s43, 55296
    s_waitcnt lgkmcnt(12)
    v_smfmac_f32_16x16x64_bf16 v[20:23], v[140:143], v[112:119], v255
    ds_read_b128 v[44:47], v238 offset:30432
    ds_read_b128 v[8:11], v238 offset:26208
    s_waitcnt lgkmcnt(12)
    v_smfmac_f32_16x16x64_bf16 v[16:19], v[152:155], v[120:127], v255
    ds_read_b128 v[12:15], v238 offset:29952
    ds_read_b128 v[104:107], v238 offset:26240
    s_waitcnt lgkmcnt(12)
    v_smfmac_f32_16x16x64_bf16 v[64:67], v[164:167], v[128:135], v255
    buffer_load_dwordx4 v28, s[24:27], s71 offen lds
    ds_read_b128 v[108:111], v238 offset:29984
    ds_read_b128 v[112:115], v238 offset:26272
    s_waitcnt lgkmcnt(12)
    v_smfmac_f32_16x16x64_bf16 v[20:23], v[144:147], v[80:87], v255
    s_waitcnt vmcnt(9)
    ds_read_b128 v[116:119], v238 offset:30016
    ds_read_b128 v[120:123], v238 offset:33696
    s_waitcnt lgkmcnt(12)
    v_smfmac_f32_16x16x64_bf16 v[16:19], v[156:159], v[48:55], v255
    ds_read_b128 v[124:127], v241 offset:27040
    ds_read_b128 v[40:43], v237 offset:30368
    buffer_load_dwordx4 v31, s[24:27], s71 offen offset:1024 lds
    s_waitcnt lgkmcnt(12)
    v_smfmac_f32_16x16x64_bf16 v[64:67], v[168:171], v[96:103], v255
    s_add_u32 s71, s43, 110592
    s_waitcnt vmcnt(9)
    s_waitcnt vmcnt(8)
    ds_read_b64_tr_b16 a[24:25], v37 offset:61440
    s_waitcnt lgkmcnt(12)
    v_mfma_f32_16x16x32_bf16 v[128:131], v[136:139], v[24:27], 0
    ds_read_b64_tr_b16 a[26:27], v37 offset:62976
    s_waitcnt lgkmcnt(12)
    v_mfma_f32_16x16x32_bf16 v[132:135], v[148:151], v[72:75], 0
    ds_read_b64_tr_b16 a[28:29], v37 offset:61472
    s_waitcnt lgkmcnt(12)
    v_mfma_f32_16x16x32_bf16 v[24:27], v[160:163], v[44:47], 0
    ds_read_b64_tr_b16 a[30:31], v37 offset:63008
    buffer_load_dwordx4 v30, s[24:27], s68 offen offset:2048 lds
    ds_read_b64_tr_b16 a[32:33], v37 offset:61504
    s_waitcnt lgkmcnt(12)
    v_smfmac_f32_16x16x64_bf16 v[128:131], v[140:143], v[8:15], v255
    s_add_u32 m0, s92, 139264
    s_add_u32 s68, s43, 165888
    ds_read_b64_tr_b16 a[34:35], v37 offset:63040
    ds_read_b128 v[80:83], v238 offset:33728
    ds_read_b128 v[84:87], v241 offset:27072
    s_waitcnt lgkmcnt(13)
    ds_read_b128 v[72:75], v237 offset:30400
    v_smfmac_f32_16x16x64_bf16 v[132:135], v[152:155], v[104:111], v255
    v_cvt_pk_bf16_f32 v44, v20, v21
    v_cvt_pk_bf16_f32 v45, v22, v23
    v_cvt_pk_bf16_f32 v46, v16, v17
    v_cvt_pk_bf16_f32 v47, v18, v19
    v_cvt_pk_bf16_f32 v48, v64, v65
    s_waitcnt lgkmcnt(12)
    v_smfmac_f32_16x16x64_bf16 v[24:27], v[164:167], v[112:119], v255
    buffer_load_dwordx4 v28, s[24:27], s69 offen lds
    v_mfma_f32_16x16x32_bf16 v[52:55], v[44:47], v[44:47], 0
    s_waitcnt vmcnt(9) lgkmcnt(11)
    ds_read_b128 v[96:99], v238 offset:33760
    ds_read_b128 v[100:103], v241 offset:27104
    v_mfma_f32_16x16x32_bf16 v[8:11], v[228:231], v[44:47], 0
    s_waitcnt lgkmcnt(12)
    ds_read_b128 v[12:15], v237 offset:30432
    ds_read_b128 v[104:107], v237 offset:26208
    v_smfmac_f32_16x16x64_bf16 v[128:131], v[144:147], v[120:127], v255
    s_waitcnt lgkmcnt(13)
    ds_read_b128 v[108:111], v237 offset:29952
    v_mfma_f32_16x16x32_bf16 v[112:115], v[136:139], v[40:43], 0
    s_waitcnt lgkmcnt(12)
    s_waitcnt vmcnt(7)
    ds_read_b64_tr_b16 a[36:37], v37 offset:0
    buffer_load_dwordx4 v29, s[24:27], s69 offen offset:1024 lds
    ds_read_b64_tr_b16 a[38:39], v37 offset:1536
    ds_read_b64_tr_b16 a[40:41], v37 offset:32
    s_waitcnt lgkmcnt(12)
    ds_read_b64_tr_b16 a[42:43], v37 offset:1568
    ds_read_b64_tr_b16 a[44:45], v37 offset:64
    ds_read_b64_tr_b16 a[46:47], v37 offset:1600
    s_waitcnt lgkmcnt(13)
    ds_read_b128 v[120:123], v237 offset:26240
    v_cvt_pk_bf16_f32 v49, v66, v67
    s_waitcnt lgkmcnt(13)
    v_smfmac_f32_16x16x64_bf16 v[132:135], v[156:159], v[80:87], v255
    ds_read_b128 v[124:127], v237 offset:29984
    v_mfma_f32_16x16x16_bf16 v[52:55], v[48:49], v[48:49], v[52:55]
    buffer_load_dwordx4 v30, s[24:27], s69 offen offset:2048 lds
    v_mfma_f32_16x16x16_bf16 v[8:11], v[228:229], v[48:49], v[8:11]
    s_waitcnt lgkmcnt(13)
    ds_read_b128 v[80:83], v237 offset:26272
    s_waitcnt lgkmcnt(12)
    v_smfmac_f32_16x16x64_bf16 v[24:27], v[168:171], v[96:103], v255
    s_add_u32 m0, s92, 151552
    s_add_u32 s69, s43, 36864
    ds_read_b128 v[84:87], v237 offset:30016
    v_mfma_f32_16x16x32_bf16 v[116:119], v[148:151], v[72:75], 0
    ds_read_b128 v[96:99], v237 offset:33696
    s_waitcnt lgkmcnt(13)
    v_mfma_f32_16x16x32_bf16 v[40:43], v[160:163], v[12:15], 0
    ds_read_b128 v[100:103], v240 offset:27040
    s_waitcnt lgkmcnt(12)
    v_smfmac_f32_16x16x64_bf16 v[112:115], v[140:143], v[104:111], v255
    buffer_load_dwordx4 v28, s[24:27], s70 offen lds
    ds_read_b128 v[104:107], v237 offset:33728
    ds_read_b128 v[108:111], v240 offset:27072
    v_cndmask_b32 v52, v52, v53, s[52:53]
    v_cndmask_b32 v52, v52, v54, s[54:55]
    v_cndmask_b32 v9, v52, v55, s[56:57]
    ds_write_b64 v249, v[8:9] offset:36864
    v_cvt_pk_bf16_f32 v72, v128, v129
    v_cvt_pk_bf16_f32 v73, v130, v131
    v_cvt_pk_bf16_f32 v74, v132, v133
    v_cvt_pk_bf16_f32 v75, v134, v135
    v_cvt_pk_bf16_f32 v52, v24, v25
    s_waitcnt lgkmcnt(7)
    v_smfmac_f32_16x16x64_bf16 v[116:119], v[152:155], v[120:127], v255
    s_waitcnt vmcnt(8)
    ds_read_b128 v[8:11], v237 offset:33760
    v_mfma_f32_16x16x32_bf16 v[124:127], v[72:75], v[72:75], 0
    ds_read_b128 v[12:15], v240 offset:27104
    v_cvt_pk_bf16_f32 v53, v26, v27
    v_mfma_f32_16x16x32_bf16 v[120:123], v[228:231], v[72:75], 0
    s_waitcnt lgkmcnt(8)
    buffer_load_dwordx4 v29, s[24:27], s70 offen offset:1024 lds
    s_waitcnt lgkmcnt(7)
    v_smfmac_f32_16x16x64_bf16 v[40:43], v[164:167], v[80:87], v255
    s_waitcnt lgkmcnt(6)
    s_waitcnt vmcnt(8)
    ds_read_b64_tr_b16 a[48:49], v37 offset:36864
    v_mfma_f32_16x16x16_bf16 v[124:127], v[52:53], v[52:53], v[124:127]
    s_waitcnt lgkmcnt(6)
    ds_read_b64_tr_b16 a[50:51], v37 offset:38400
    ds_read_b64_tr_b16 a[52:53], v37 offset:36896
    v_mfma_f32_16x16x16_bf16 v[120:123], v[228:229], v[52:53], v[120:123]
    s_waitcnt lgkmcnt(7)
    ds_read_b64_tr_b16 a[54:55], v37 offset:38432
    ds_read_b64_tr_b16 a[56:57], v37 offset:36928
    v_smfmac_f32_16x16x64_bf16 v[112:115], v[144:147], v[96:103], v255
    s_waitcnt lgkmcnt(8)
    ds_read_b64_tr_b16 a[58:59], v37 offset:38464
    v_smfmac_f32_16x16x64_bf16 v[116:119], v[156:159], v[104:111], v255
    v_cndmask_b32 v124, v124, v125, s[52:53]
    v_cndmask_b32 v124, v124, v126, s[54:55]
    v_cndmask_b32 v121, v124, v127, s[56:57]
    buffer_load_dwordx4 v30, s[24:27], s70 offen offset:2048 lds
    s_waitcnt lgkmcnt(6)
    v_smfmac_f32_16x16x64_bf16 v[40:43], v[168:171], v[8:15], v255
    s_waitcnt lgkmcnt(5)
    s_add_u32 m0, s92, 126976
    ds_write_b64 v249, v[120:121] offset:37376
    s_add_u32 s70, s43, 73728
    v_cvt_pk_bf16_f32 v80, v112, v113
    v_cvt_pk_bf16_f32 v81, v114, v115
    v_cvt_pk_bf16_f32 v82, v116, v117
    v_cvt_pk_bf16_f32 v83, v118, v119
    v_cvt_pk_bf16_f32 v50, v40, v41
    v_cvt_pk_bf16_f32 v51, v42, v43
    v_mfma_f32_16x16x32_bf16 v[84:87], v[80:83], v[80:83], 0
    s_waitcnt lgkmcnt(1)
    buffer_load_dwordx4 v28, s[24:27], s71 offen lds
    v_mfma_f32_16x16x32_bf16 v[96:99], v[228:231], v[80:83], 0
    s_waitcnt vmcnt(9)
    s_nop 1
    v_mfma_f32_16x16x16_bf16 v[84:87], v[50:51], v[50:51], v[84:87]
    s_nop 1
    v_mfma_f32_16x16x16_bf16 v[96:99], v[228:229], v[50:51], v[96:99]
    buffer_load_dwordx4 v29, s[24:27], s71 offen offset:1024 lds
    s_waitcnt vmcnt(8)
    ds_read_b64_tr_b16 a[60:61], v37 offset:18432
    ds_read_b64_tr_b16 a[62:63], v37 offset:19968
    ds_read_b64_tr_b16 a[64:65], v37 offset:18464
    ds_read_b64_tr_b16 a[66:67], v37 offset:20000
    ds_read_b64_tr_b16 a[68:69], v37 offset:18496
    ds_read_b64_tr_b16 a[70:71], v37 offset:20032
    v_cndmask_b32 v84, v84, v85, s[52:53]
    v_cndmask_b32 v84, v84, v86, s[54:55]
    v_cndmask_b32 v97, v84, v87, s[56:57]
    ds_write_b64 v249, v[96:97] offset:37120
    ds_read_b128 v[84:87], v247 offset:7168
    buffer_load_dwordx4 v30, s[24:27], s71 offen offset:2048 lds
    ds_read_b128 v[100:103], v247 offset:8192
    ds_read_b128 v[96:99], v247 offset:9216
    ds_read_b128 v[104:107], v247 offset:1024
    ds_read_b128 v[108:111], v247 offset:2048
    s_add_u32 m0, s92, 139264
    s_add_u32 s71, s43, 147456
    s_waitcnt lgkmcnt(5)
    s_barrier
    ds_read_b128 v[124:127], v247 offset:3072
    ds_read_b128 v[120:123], v247 offset:60416
    ds_read_b128 v[8:11], v247 offset:61440
    s_waitcnt lgkmcnt(7)
    v_mfma_f32_16x16x32_bf16 v[12:15], a[0:3], v[84:87], 0
    s_waitcnt lgkmcnt(6)
    v_mfma_f32_16x16x32_bf16 v[12:15], a[12:15], v[100:103], v[12:15]
    s_waitcnt vmcnt(8)
    s_waitcnt lgkmcnt(5)
    v_mfma_f32_16x16x32_bf16 v[12:15], a[24:27], v[96:99], v[12:15]
    s_waitcnt vmcnt(6)
    ds_read_b64_tr_b16 a[144:145], v37 offset:49152
    ds_read_b64_tr_b16 a[146:147], v37 offset:50688
    ds_read_b64_tr_b16 a[148:149], v37 offset:49184
    ds_read_b64_tr_b16 a[150:151], v37 offset:50720
    ds_read_b64_tr_b16 a[152:153], v37 offset:49216
    ds_read_b64_tr_b16 a[154:155], v37 offset:50752
    s_waitcnt lgkmcnt(7)
    v_add_f32 v120, v120, v122
    v_add_f32 v121, v121, v123
    s_waitcnt lgkmcnt(6)
    v_add_f32 v8, v8, v10
    v_add_f32 v9, v9, v11
    v_add_f32 v120, v120, v8
    v_add_f32 v121, v121, v9
    v_mul_f32 v122, s45, v120
    v_mul_f32 v121, s45, v121
    v_fma_f32 v121, -v122, v122, v121
    v_max_f32 v121, 0, v121
    v_add_f32 v121, s46, v121
    v_rsq_f32 v120, v121
    s_nop 0
    v_mul_f32 v121, -v122, v120
    ds_write_b64 v245, v[120:121] offset:19456
    s_waitcnt lgkmcnt(1)
    buffer_load_dwordx4 v28, s[24:27], s68 offen lds
    ds_read_b64 v[8:9], v248 offset:0
    ds_read_b64 v[10:11], v248 offset:256
    ds_read_b64 v[122:123], v248 offset:512
    ds_read_b64 v[120:121], v248 offset:768
    buffer_load_dwordx4 v29, s[24:27], s68 offen offset:1024 lds
    s_waitcnt lgkmcnt(3)
    v_fma_f32 v20, v20, v8, v9
    v_fma_f32 v21, v21, v8, v9
    v_fma_f32 v22, v22, v8, v9
    v_fma_f32 v23, v23, v8, v9
    v_fma_f32 v16, v16, v8, v9
    s_waitcnt lgkmcnt(0)
    v_fma_f32 v68, v68, v120, v121
    v_fma_f32 v69, v69, v120, v121
    v_fma_f32 v70, v70, v120, v121
    v_fma_f32 v71, v71, v120, v121
    buffer_load_dwordx4 v30, s[24:27], s68 offen offset:2048 lds
    s_waitcnt vmcnt(6)
    ds_read_b64_tr_b16 a[156:157], v37 offset:61440
    ds_read_b64_tr_b16 a[158:159], v37 offset:62976
    ds_read_b64_tr_b16 a[160:161], v37 offset:61472
    ds_read_b64_tr_b16 a[162:163], v37 offset:63008
    ds_read_b64_tr_b16 a[164:165], v37 offset:61504
    ds_read_b64_tr_b16 a[166:167], v37 offset:63040
    s_add_u32 m0, s92, 33696
    s_add_u32 s68, s43, 184320
    v_fma_f32 v0, v0, v120, v121
    v_fma_f32 v1, v1, v120, v121
    v_fma_f32 v2, v2, v120, v121
    v_fma_f32 v3, v3, v120, v121
    v_fma_f32 v4, v4, v120, v121
    v_fma_f32 v5, v5, v120, v121
    v_fma_f32 v6, v6, v120, v121
    buffer_load_dwordx4 v28, s[24:27], s69 offen lds
    v_fma_f32 v7, v7, v120, v121
    v_cvt_pk_bf16_f32 v68, v68, v69
    v_cvt_pk_bf16_f32 v69, v70, v71
    v_cvt_pk_bf16_f32 v70, v0, v1
    v_cvt_pk_bf16_f32 v71, v2, v3
    v_mfma_f32_16x16x32_bf16 v[0:3], a[0:3], v[104:107], 0
    s_waitcnt lgkmcnt(5)
    ds_write_b128 v250, v[68:71] offset:0
    v_mfma_f32_16x16x32_bf16 v[0:3], a[12:15], v[108:111], v[0:3]
    s_waitcnt lgkmcnt(1)
    v_cvt_pk_bf16_f32 v4, v4, v5
    v_fma_f32 v17, v17, v8, v9
    v_mfma_f32_16x16x32_bf16 v[0:3], a[24:27], v[124:127], v[0:3]
    buffer_load_dwordx4 v31, s[24:27], s69 offen offset:1024 lds
    v_mfma_f32_16x16x32_bf16 v[68:71], a[4:7], v[104:107], 0
    s_add_u32 s69, s43, 768
    v_cvt_pk_bf16_f32 v5, v6, v7
    v_fma_f32 v18, v18, v8, v9
    v_mfma_f32_16x16x32_bf16 v[68:71], a[16:19], v[108:111], v[68:71]
    s_waitcnt vmcnt(7)
    ds_write_b64 v251, v[4:5] offset:0
    v_mfma_f32_16x16x32_bf16 v[68:71], a[28:31], v[124:127], v[68:71]
    v_fma_f32 v19, v19, v8, v9
    v_fma_f32 v64, v64, v8, v9
    v_mfma_f32_16x16x32_bf16 v[4:7], a[8:11], v[104:107], 0
    buffer_load_dwordx4 v30, s[24:27], s70 offen offset:2048 lds
    v_mfma_f32_16x16x32_bf16 v[4:7], a[20:23], v[108:111], v[4:7]
    s_add_u32 m0, s92, 45984
    s_waitcnt vmcnt(6)
    ds_read_b64_tr_b16 a[168:169], v37 offset:36864
    v_mfma_f32_16x16x32_bf16 v[4:7], a[32:35], v[124:127], v[4:7]
    s_add_u32 s70, s43, 56064
    ds_read_b64_tr_b16 a[170:171], v37 offset:38400
    ds_read_b64_tr_b16 a[172:173], v37 offset:36896
    ds_read_b64_tr_b16 a[174:175], v37 offset:38432
    ds_read_b64_tr_b16 a[176:177], v37 offset:36928
    ds_read_b64_tr_b16 a[178:179], v37 offset:38464
    ds_read_b128 v[124:127], v247 offset:4096
    ds_read_b128 v[104:107], v247 offset:5120
    v_fma_f32 v65, v65, v8, v9
    v_fma_f32 v66, v66, v8, v9
    v_fma_f32 v67, v67, v8, v9
    buffer_load_dwordx4 v28, s[24:27], s71 offen lds
    v_cvt_pk_bf16_f32 v20, v20, v21
    v_cvt_pk_bf16_f32 v21, v22, v23
    v_cvt_pk_bf16_f32 v22, v16, v17
    v_cvt_pk_bf16_f32 v23, v18, v19
    v_mfma_f32_16x16x32_bf16 v[108:111], a[4:7], v[84:87], 0
    ds_write_b128 v245, v[20:23] offset:25600
    v_mfma_f32_16x16x32_bf16 v[108:111], a[16:19], v[100:103], v[108:111]
    s_waitcnt lgkmcnt(5)
    v_cvt_pk_bf16_f32 v64, v64, v65
    v_cvt_pk_bf16_f32 v65, v66, v67
    v_mfma_f32_16x16x32_bf16 v[108:111], a[28:31], v[96:99], v[108:111]
    s_waitcnt lgkmcnt(3)
    buffer_load_dwordx4 v31, s[24:27], s71 offen offset:1024 lds
    v_mfma_f32_16x16x32_bf16 v[16:19], a[8:11], v[84:87], 0
    s_waitcnt lgkmcnt(2)
    s_barrier
    ds_read_b128 v[20:23], v247 offset:10240
    v_mfma_f32_16x16x32_bf16 v[16:19], a[20:23], v[100:103], v[16:19]
    s_waitcnt lgkmcnt(2)
    ds_read_b128 v[84:87], v247 offset:11264
    ds_read_b128 v[100:103], v247 offset:6144
    v_mfma_f32_16x16x32_bf16 v[16:19], a[32:35], v[96:99], v[16:19]
    s_add_u32 s71, s43, 111360
    ds_read_b128 v[96:99], v247 offset:12288
    v_fma_f32 v112, v112, v10, v11
    v_mfma_f32_16x16x32_bf16 v[0:3], a[36:39], v[124:127], v[0:3]
    ds_write_b64 v246, v[64:65] offset:25600
    v_mfma_f32_16x16x32_bf16 v[0:3], a[48:51], v[104:107], v[0:3]
    v_fma_f32 v113, v113, v10, v11
    v_fma_f32 v114, v114, v10, v11
    v_mfma_f32_16x16x32_bf16 v[68:71], a[40:43], v[124:127], v[68:71]
    v_fma_f32 v115, v115, v10, v11
    v_fma_f32 v116, v116, v10, v11
    v_mfma_f32_16x16x32_bf16 v[68:71], a[52:55], v[104:107], v[68:71]
    s_waitcnt lgkmcnt(4)
    v_fma_f32 v117, v117, v10, v11
    v_mfma_f32_16x16x32_bf16 v[12:15], a[36:39], v[20:23], v[12:15]
    s_waitcnt lgkmcnt(3)
    v_fma_f32 v118, v118, v10, v11
    v_mfma_f32_16x16x32_bf16 v[12:15], a[48:51], v[84:87], v[12:15]
    buffer_load_dwordx4 v30, s[24:27], s68 offen offset:2048 lds
    v_mfma_f32_16x16x32_bf16 v[108:111], a[40:43], v[20:23], v[108:111]
    s_waitcnt lgkmcnt(2)
    v_fma_f32 v119, v119, v10, v11
    v_fma_f32 v40, v40, v10, v11
    v_mfma_f32_16x16x32_bf16 v[108:111], a[52:55], v[84:87], v[108:111]
    s_waitcnt lgkmcnt(1)
    ds_read_b128 v[64:67], v38 offset:0
    v_fma_f32 v41, v41, v10, v11
    v_mfma_f32_16x16x32_bf16 v[108:111], a[64:67], v[96:99], v[108:111]
    s_add_u32 m0, s92, 151552
    v_fma_f32 v128, v128, v122, v123
    v_fma_f32 v42, v42, v10, v11
    v_mfma_f32_16x16x32_bf16 v[12:15], a[60:63], v[96:99], v[12:15]
    s_add_u32 s68, s43, 166656
    v_fma_f32 v129, v129, v122, v123
    v_fma_f32 v43, v43, v10, v11
    v_mfma_f32_16x16x32_bf16 v[0:3], a[60:63], v[100:103], v[0:3]
    buffer_load_dwordx4 v28, s[24:27], s69 offen lds
    v_mfma_f32_16x16x32_bf16 v[16:19], a[44:47], v[20:23], v[16:19]
    s_waitcnt vmcnt(9)
    ds_read_b128 v[8:11], v38 offset:256
    ds_read_b128 v[20:23], v38 offset:512
    v_mfma_f32_16x16x32_bf16 v[16:19], a[56:59], v[84:87], v[16:19]
    v_cvt_pk_bf16_f32 v12, v12, v13
    v_cvt_pk_bf16_f32 v13, v14, v15
    v_mfma_f32_16x16x32_bf16 v[16:19], a[68:71], v[96:99], v[16:19]
    v_cvt_pk_bf16_f32 v0, v0, v1
    v_cvt_pk_bf16_f32 v14, v108, v109
    v_mfma_f32_16x16x32_bf16 v[68:71], a[64:67], v[100:103], v[68:71]
    s_waitcnt lgkmcnt(2)
    v_cvt_pk_bf16_f32 v1, v2, v3
    v_cvt_pk_bf16_f32 v15, v110, v111
    v_mfma_f32_16x16x32_bf16 v[4:7], a[44:47], v[124:127], v[4:7]
    buffer_load_dwordx4 v29, s[24:27], s69 offen offset:1024 lds
    v_mfma_f32_16x16x32_bf16 v[4:7], a[56:59], v[104:107], v[4:7]
    s_waitcnt vmcnt(9)
    s_waitcnt vmcnt(8)
    ds_read_b64_tr_b16 a[180:181], v37 offset:49152
    v_mfma_f32_16x16x32_bf16 v[4:7], a[68:71], v[100:103], v[4:7]
    ds_read_b64_tr_b16 a[182:183], v37 offset:50688
    ds_read_b64_tr_b16 a[184:185], v37 offset:49184
    v_mfma_f32_16x16x32_bf16 v[84:87], a[0:3], v[64:67], 0
    s_waitcnt lgkmcnt(4)
    ds_read_b64_tr_b16 a[186:187], v37 offset:50720
    ds_read_b64_tr_b16 a[188:189], v37 offset:49216
    v_mfma_f32_16x16x32_bf16 v[84:87], a[12:15], v[8:11], v[84:87]
    s_waitcnt lgkmcnt(5)
    ds_read_b64_tr_b16 a[190:191], v37 offset:50752
    v_cvt_pk_bf16_f32 v2, v68, v69
    v_mfma_f32_16x16x32_bf16 v[84:87], a[24:27], v[20:23], v[84:87]
    buffer_load_dwordx4 v30, s[24:27], s69 offen offset:2048 lds
    v_mfma_f32_16x16x32_bf16 v[124:127], a[4:7], v[64:67], 0
    s_add_u32 m0, s92, 126976
    v_cvt_pk_bf16_f32 v3, v70, v71
    v_cvt_pk_bf16_f32 v4, v4, v5
    v_mfma_f32_16x16x32_bf16 v[124:127], a[16:19], v[8:11], v[124:127]
    s_add_u32 s69, s43, 37632
    v_cvt_pk_bf16_f32 v5, v6, v7
    v_cvt_pk_bf16_f32 v6, v16, v17
    v_mfma_f32_16x16x32_bf16 v[124:127], a[28:31], v[20:23], v[124:127]
    s_waitcnt lgkmcnt(5)
    v_cvt_pk_bf16_f32 v7, v18, v19
    v_fma_f32 v130, v130, v122, v123
    v_cvt_pk_bf16_f32 v112, v112, v113
    v_fma_f32 v131, v131, v122, v123
    v_cvt_pk_bf16_f32 v113, v114, v115
    v_fma_f32 v132, v132, v122, v123
    v_cvt_pk_bf16_f32 v114, v116, v117
    buffer_load_dwordx4 v28, s[24:27], s70 offen lds
    v_fma_f32 v133, v133, v122, v123
    v_cvt_pk_bf16_f32 v115, v118, v119
    v_mfma_f32_16x16x32_bf16 v[68:71], a[8:11], v[64:67], 0
    s_waitcnt vmcnt(9) lgkmcnt(0)
    ds_write_b128 v245, v[112:115] offset:31744
    v_mfma_f32_16x16x32_bf16 v[68:71], a[20:23], v[8:11], v[68:71]
    v_fma_f32 v134, v134, v122, v123
    v_cvt_pk_bf16_f32 v40, v40, v41
    v_mfma_f32_16x16x32_bf16 v[68:71], a[32:35], v[20:23], v[68:71]
    buffer_load_dwordx4 v29, s[24:27], s70 offen offset:1024 lds
    v_mfma_f32_16x16x32_bf16 v[16:19], a[144:147], v[64:67], 0
    v_fma_f32 v135, v135, v122, v123
    v_cvt_pk_bf16_f32 v41, v42, v43
    v_mfma_f32_16x16x32_bf16 v[16:19], a[156:159], v[8:11], v[16:19]
    s_waitcnt vmcnt(9)
    s_waitcnt vmcnt(8)
    ds_read_b64_tr_b16 a[192:193], v36 offset:33696
    v_mfma_f32_16x16x32_bf16 v[16:19], a[168:171], v[20:23], v[16:19]
    ds_read_b64_tr_b16 a[194:195], v36 offset:35232
    ds_read_b64_tr_b16 a[196:197], v36 offset:33728
    ds_read_b64_tr_b16 a[198:199], v36 offset:35264
    ds_read_b64_tr_b16 a[200:201], v36 offset:33760
    ds_read_b64_tr_b16 a[202:203], v36 offset:35296
    ds_write_b64 v246, v[40:41] offset:31744
    v_mfma_f32_16x16x32_bf16 v[40:43], a[148:151], v[64:67], 0
    buffer_load_dwordx4 v30, s[24:27], s70 offen offset:2048 lds
    v_mfma_f32_16x16x32_bf16 v[40:43], a[160:163], v[8:11], v[40:43]
    s_add_u32 m0, s92, 139264
    v_fma_f32 v24, v24, v122, v123
    v_fma_f32 v25, v25, v122, v123
    v_mfma_f32_16x16x32_bf16 v[40:43], a[172:175], v[20:23], v[40:43]
    s_add_u32 s70, s43, 74496
    v_fma_f32 v26, v26, v122, v123
    v_fma_f32 v27, v27, v122, v123
    v_mfma_f32_16x16x32_bf16 v[120:123], a[152:155], v[64:67], 0
    s_waitcnt lgkmcnt(6)
    ds_read_b128 v[64:67], v38 offset:768
    v_cvt_pk_bf16_f32 v128, v128, v129
    v_mfma_f32_16x16x32_bf16 v[120:123], a[164:167], v[8:11], v[120:123]
    s_waitcnt lgkmcnt(5)
    ds_read_b128 v[8:11], v38 offset:1024
    v_cvt_pk_bf16_f32 v129, v130, v131
    v_mfma_f32_16x16x32_bf16 v[120:123], a[176:179], v[20:23], v[120:123]
    s_waitcnt vmcnt(8) lgkmcnt(4)
    buffer_load_dwordx4 v28, s[24:27], s71 offen lds
    ds_read_b128 v[20:23], v38 offset:1280
    v_cvt_pk_bf16_f32 v130, v132, v133
    v_cvt_pk_bf16_f32 v131, v134, v135
    v_cvt_pk_bf16_f32 v24, v24, v25
    v_cvt_pk_bf16_f32 v25, v26, v27
    ds_write_b128 v245, v[128:131] offset:37888
    s_waitcnt lgkmcnt(3)
    v_mfma_f32_16x16x32_bf16 v[120:123], a[188:191], v[64:67], v[120:123]
    s_waitcnt lgkmcnt(2)
    v_mfma_f32_16x16x32_bf16 v[120:123], a[200:203], v[8:11], v[120:123]
    s_waitcnt vmcnt(8)
    v_mfma_f32_16x16x32_bf16 v[84:87], a[36:39], v[64:67], v[84:87]
    ds_write_b64 v246, v[24:25] offset:37888
    v_mfma_f32_16x16x32_bf16 v[84:87], a[48:51], v[8:11], v[84:87]
    s_waitcnt lgkmcnt(2)
    buffer_load_dwordx4 v29, s[24:27], s71 offen offset:1024 lds
    v_mfma_f32_16x16x32_bf16 v[84:87], a[60:63], v[20:23], v[84:87]
    s_waitcnt vmcnt(8)
    ds_read_b64_tr_b16 a[204:205], v36 offset:45984
    v_mfma_f32_16x16x32_bf16 v[124:127], a[40:43], v[64:67], v[124:127]
    ds_read_b64_tr_b16 a[206:207], v36 offset:47520
    ds_read_b64_tr_b16 a[208:209], v36 offset:46016
    v_mfma_f32_16x16x32_bf16 v[124:127], a[52:55], v[8:11], v[124:127]
    ds_read_b64_tr_b16 a[210:211], v36 offset:47552
    ds_read_b64_tr_b16 a[212:213], v36 offset:46048
    v_mfma_f32_16x16x32_bf16 v[124:127], a[64:67], v[20:23], v[124:127]
    ds_read_b64_tr_b16 a[214:215], v36 offset:47584
    ds_read_b128 v[24:27], v247 offset:7168
    v_mfma_f32_16x16x32_bf16 v[68:71], a[44:47], v[64:67], v[68:71]
    buffer_load_dwordx4 v30, s[24:27], s71 offen offset:2048 lds
    v_mfma_f32_16x16x32_bf16 v[68:71], a[56:59], v[8:11], v[68:71]
    s_add_u32 m0, s92, 33696
    ds_read_b128 v[96:99], v247 offset:8192
    ds_read_b128 v[100:103], v247 offset:9216
    v_mfma_f32_16x16x32_bf16 v[68:71], a[68:71], v[20:23], v[68:71]
    s_add_u32 s71, s43, 148224
    v_cvt_pk_bf16_f32 v204, v84, v85
    v_cvt_pk_bf16_f32 v205, v86, v87
    v_mfma_f32_16x16x32_bf16 v[16:19], a[180:183], v[64:67], v[16:19]
    s_waitcnt lgkmcnt(8)
    ds_read_b128 v[84:87], v247 offset:10240
    v_cvt_pk_bf16_f32 v206, v124, v125
    v_mfma_f32_16x16x32_bf16 v[16:19], a[192:195], v[8:11], v[16:19]
    s_waitcnt lgkmcnt(7)
    v_cvt_pk_bf16_f32 v207, v126, v127
    v_cvt_pk_bf16_f32 v208, v68, v69
    v_mfma_f32_16x16x32_bf16 v[16:19], a[204:207], v[20:23], v[16:19]
    s_waitcnt lgkmcnt(5)
    buffer_load_dwordx4 v28, s[24:27], s68 offen lds
    v_mfma_f32_16x16x32_bf16 v[40:43], a[184:187], v[64:67], v[40:43]
    s_waitcnt lgkmcnt(4)
    ds_read_b128 v[124:127], v247 offset:11264
    ds_read_b128 v[64:67], v247 offset:12288
    v_mfma_f32_16x16x32_bf16 v[40:43], a[196:199], v[8:11], v[40:43]
    s_waitcnt vmcnt(9) lgkmcnt(5)
    v_cvt_pk_bf16_f32 v209, v70, v71
    v_cvt_pk_bf16_f32 v210, v16, v17
    v_mfma_f32_16x16x32_bf16 v[40:43], a[208:211], v[20:23], v[40:43]
    s_waitcnt lgkmcnt(4)
    v_cvt_pk_bf16_f32 v211, v18, v19
    v_mfma_f32_16x16x32_bf16 v[120:123], a[212:215], v[20:23], v[120:123]
    s_waitcnt lgkmcnt(3)
    v_mfma_f32_16x16x32_bf16 v[8:11], a[144:147], v[24:27], 0
    s_waitcnt lgkmcnt(2)
    buffer_load_dwordx4 v29, s[24:27], s68 offen offset:1024 lds
    v_mfma_f32_16x16x32_bf16 v[8:11], a[156:159], v[96:99], v[8:11]
    s_waitcnt vmcnt(8)
    ds_read_b64_tr_b16 a[72:73], v37 offset:61440
    v_mfma_f32_16x16x32_bf16 v[8:11], a[168:171], v[100:103], v[8:11]
    ds_read_b64_tr_b16 a[74:75], v37 offset:62976
    ds_read_b64_tr_b16 a[76:77], v37 offset:61472
    v_mfma_f32_16x16x32_bf16 v[8:11], a[180:183], v[84:87], v[8:11]
    s_waitcnt lgkmcnt(4)
    ds_read_b64_tr_b16 a[78:79], v37 offset:63008
    ds_read_b64_tr_b16 a[80:81], v37 offset:61504
    v_mfma_f32_16x16x32_bf16 v[8:11], a[192:195], v[124:127], v[8:11]
    s_waitcnt lgkmcnt(5)
    ds_read_b64_tr_b16 a[82:83], v37 offset:63040
    ds_read_b128 v[68:71], v247 offset:13312
    v_mfma_f32_16x16x32_bf16 v[8:11], a[204:207], v[64:67], v[8:11]
    ds_read_b128 v[108:111], v247 offset:14336
    buffer_load_dwordx4 v30, s[24:27], s68 offen offset:2048 lds
    v_mfma_f32_16x16x32_bf16 v[104:107], a[148:151], v[24:27], 0
    s_add_u32 m0, s92, 45984
    ds_read_b128 v[116:119], v247 offset:15360
    v_cvt_pk_bf16_f32 v212, v40, v41
    v_mfma_f32_16x16x32_bf16 v[104:107], a[160:163], v[96:99], v[104:107]
    s_add_u32 s68, s43, 185088
    v_cvt_pk_bf16_f32 v213, v42, v43
    v_cvt_pk_bf16_f32 v214, v120, v121
    v_mfma_f32_16x16x32_bf16 v[104:107], a[172:175], v[100:103], v[104:107]
    s_waitcnt lgkmcnt(7)
    v_cvt_pk_bf16_f32 v215, v122, v123
    v_cvt_pk_bf16_f32 v8, v8, v9
    v_mfma_f32_16x16x32_bf16 v[104:107], a[184:187], v[84:87], v[104:107]
    s_waitcnt lgkmcnt(5)
    v_cvt_pk_bf16_f32 v9, v10, v11
    v_mfma_f32_16x16x32_bf16 v[104:107], a[196:199], v[124:127], v[104:107]
    s_waitcnt lgkmcnt(3)
    buffer_load_dwordx4 v28, s[24:27], s69 offen lds
    v_mfma_f32_16x16x32_bf16 v[104:107], a[208:211], v[64:67], v[104:107]
    s_waitcnt lgkmcnt(2)
    v_mfma_f32_16x16x32_bf16 v[112:115], a[0:3], v[68:71], 0
    s_waitcnt vmcnt(9) lgkmcnt(1)
    v_mfma_f32_16x16x32_bf16 v[112:115], a[12:15], v[108:111], v[112:115]
    s_waitcnt lgkmcnt(0)
    v_mfma_f32_16x16x32_bf16 v[112:115], a[24:27], v[116:119], v[112:115]
    v_mfma_f32_16x16x32_bf16 v[40:43], a[4:7], v[68:71], 0
    buffer_load_dwordx4 v31, s[24:27], s69 offen offset:1024 lds
    v_mfma_f32_16x16x32_bf16 v[40:43], a[16:19], v[108:111], v[40:43]
    s_waitcnt vmcnt(9)
    s_waitcnt vmcnt(8)
    ds_read_b64_tr_b16 a[84:85], v37 offset:36864
    v_mfma_f32_16x16x32_bf16 v[40:43], a[28:31], v[116:119], v[40:43]
    s_add_u32 s69, s43, 0
    ds_read_b64_tr_b16 a[86:87], v37 offset:38400
    ds_read_b64_tr_b16 a[88:89], v37 offset:36896
    v_mfma_f32_16x16x32_bf16 v[120:123], a[8:11], v[68:71], 0
    ds_read_b64_tr_b16 a[90:91], v37 offset:38432
    ds_read_b64_tr_b16 a[92:93], v37 offset:36928
    v_mfma_f32_16x16x32_bf16 v[120:123], a[20:23], v[108:111], v[120:123]
    ds_read_b64_tr_b16 a[94:95], v37 offset:38464
    ds_read_b128 v[68:71], v247 offset:16384
    v_mfma_f32_16x16x32_bf16 v[120:123], a[32:35], v[116:119], v[120:123]
    buffer_load_dwordx4 v30, s[24:27], s70 offen offset:2048 lds
    ds_read_b128 v[108:111], v247 offset:17408
    ds_read_b128 v[116:119], v247 offset:18432
    s_add_u32 m0, s92, 151552
    s_add_u32 s70, s43, 18432
    v_cvt_pk_bf16_f32 v10, v104, v105
    v_cvt_pk_bf16_f32 v11, v106, v107
    v_mfma_f32_16x16x32_bf16 v[104:107], a[152:155], v[24:27], 0
    s_waitcnt lgkmcnt(8)
    v_cmp_gt_u32 vcc, 64768, v247
    v_mfma_f32_16x16x32_bf16 v[104:107], a[164:167], v[96:99], v[104:107]
    s_waitcnt lgkmcnt(7)
    v_mfma_f32_16x16x32_bf16 v[104:107], a[176:179], v[100:103], v[104:107]
    s_waitcnt lgkmcnt(5)
    v_mfma_f32_16x16x32_bf16 v[104:107], a[188:191], v[84:87], v[104:107]
    s_waitcnt lgkmcnt(3)
    v_mfma_f32_16x16x32_bf16 v[104:107], a[200:203], v[124:127], v[104:107]
    s_waitcnt vmcnt(8) lgkmcnt(2)
    ds_read_b128 v[24:27], v247 offset:1024
    v_mfma_f32_16x16x32_bf16 v[104:107], a[212:215], v[64:67], v[104:107]
    s_waitcnt lgkmcnt(2)
    ds_read_b128 v[84:87], v247 offset:2048
    v_mfma_f32_16x16x32_bf16 v[112:115], a[36:39], v[68:71], v[112:115]
    s_waitcnt lgkmcnt(2)
    buffer_load_dwordx4 v28, s[24:27], s71 offen lds
    v_mfma_f32_16x16x32_bf16 v[112:115], a[48:51], v[108:111], v[112:115]
    ds_read_b128 v[124:127], v247 offset:3072
    ds_read_b128 v[64:67], v247 offset:4096
    v_mfma_f32_16x16x32_bf16 v[112:115], a[60:63], v[116:119], v[112:115]
    ds_read_b128 v[132:135], v247 offset:5120
    v_mfma_f32_16x16x32_bf16 v[40:43], a[40:43], v[68:71], v[40:43]
    ds_read_b128 v[128:131], v247 offset:6144
    v_mfma_f32_16x16x32_bf16 v[40:43], a[52:55], v[108:111], v[40:43]
    v_mfma_f32_16x16x32_bf16 v[40:43], a[64:67], v[116:119], v[40:43]
    s_waitcnt lgkmcnt(5)
    buffer_load_dwordx4 v31, s[24:27], s71 offen offset:1024 lds
    v_mfma_f32_16x16x32_bf16 v[120:123], a[44:47], v[68:71], v[120:123]
    s_waitcnt lgkmcnt(4)
    s_waitcnt vmcnt(8)
    ds_read_b64_tr_b16 a[96:97], v37 offset:49152
    v_mfma_f32_16x16x32_bf16 v[120:123], a[56:59], v[108:111], v[120:123]
    s_add_u32 s71, s43, 36864
    ds_read_b64_tr_b16 a[98:99], v37 offset:50688
    ds_read_b64_tr_b16 a[100:101], v37 offset:49184
    v_mfma_f32_16x16x32_bf16 v[120:123], a[68:71], v[116:119], v[120:123]
    s_waitcnt lgkmcnt(6)
    ds_read_b64_tr_b16 a[102:103], v37 offset:50720
    ds_read_b64_tr_b16 a[104:105], v37 offset:49216
    v_mfma_f32_16x16x32_bf16 v[68:71], a[144:147], v[24:27], 0
    s_waitcnt lgkmcnt(7)
    ds_read_b64_tr_b16 a[106:107], v37 offset:50752
    v_cvt_pk_bf16_f32 v112, v112, v113
    v_mfma_f32_16x16x32_bf16 v[68:71], a[156:159], v[84:87], v[68:71]
    s_waitcnt lgkmcnt(7)
    buffer_load_dwordx4 v30, s[24:27], s68 offen offset:2048 lds
    v_mfma_f32_16x16x32_bf16 v[68:71], a[168:171], v[124:127], v[68:71]
    s_waitcnt lgkmcnt(6)
    v_cvt_pk_bf16_f32 v113, v114, v115
    v_cvt_pk_bf16_f32 v114, v40, v41
    v_mfma_f32_16x16x32_bf16 v[68:71], a[180:183], v[64:67], v[68:71]
    s_add_u32 m0, s92, 126976
    v_cvt_pk_bf16_f32 v115, v42, v43
    v_cvt_pk_bf16_f32 v120, v120, v121
    v_mfma_f32_16x16x32_bf16 v[68:71], a[192:195], v[132:135], v[68:71]
    s_waitcnt lgkmcnt(5)
    v_cvt_pk_bf16_f32 v121, v122, v123
    s_add_u32 s68, s43, 55296
    v_mfma_f32_16x16x32_bf16 v[68:71], a[204:207], v[128:131], v[68:71]
    s_waitcnt lgkmcnt(3)
    v_mfma_f32_16x16x32_bf16 v[108:111], a[148:151], v[24:27], 0
    s_waitcnt lgkmcnt(1)
    buffer_load_dwordx4 v32, s[28:31], s69 offen lds
    v_mfma_f32_16x16x32_bf16 v[108:111], a[160:163], v[84:87], v[108:111]
    s_waitcnt lgkmcnt(0)
    ds_read_b128 v[116:119], v247 offset:1024
    v_mfma_f32_16x16x32_bf16 v[108:111], a[172:175], v[124:127], v[108:111]
    s_waitcnt vmcnt(9)
    ds_read_b128 v[28:31], v247 offset:2048
    v_cvt_pk_bf16_f32 v68, v68, v69
    v_mfma_f32_16x16x32_bf16 v[108:111], a[184:187], v[64:67], v[108:111]
    ds_read_b128 v[40:43], v247 offset:3072
    v_cvt_pk_bf16_f32 v69, v70, v71
    v_mfma_f32_16x16x32_bf16 v[108:111], a[196:199], v[132:135], v[108:111]
    v_mfma_f32_16x16x32_bf16 v[108:111], a[208:211], v[128:131], v[108:111]
    buffer_load_dwordx4 v33, s[28:31], s69 offen offset:1024 lds
    v_mfma_f32_16x16x32_bf16 v[16:19], a[152:155], v[24:27], 0
    s_waitcnt vmcnt(8)
    ds_read_b64_tr_b16 a[108:109], v36 offset:33696
    v_mfma_f32_16x16x32_bf16 v[16:19], a[164:167], v[84:87], v[16:19]
    ds_read_b64_tr_b16 a[110:111], v36 offset:35232
    ds_read_b64_tr_b16 a[112:113], v36 offset:33728
    v_mfma_f32_16x16x32_bf16 v[16:19], a[176:179], v[124:127], v[16:19]
    s_waitcnt lgkmcnt(5)
    ds_read_b64_tr_b16 a[114:115], v36 offset:35264
    ds_read_b64_tr_b16 a[116:117], v36 offset:33760
    v_mfma_f32_16x16x32_bf16 v[16:19], a[188:191], v[64:67], v[16:19]
    s_waitcnt lgkmcnt(6)
    ds_read_b64_tr_b16 a[118:119], v36 offset:35296
    v_cvt_pk_bf16_f32 v70, v108, v109
    v_mfma_f32_16x16x32_bf16 v[16:19], a[200:203], v[132:135], v[16:19]
    s_waitcnt lgkmcnt(6)
    buffer_load_dwordx4 v34, s[28:31], s69 offen offset:2048 lds
    v_mfma_f32_16x16x32_bf16 v[16:19], a[212:215], v[128:131], v[16:19]
    s_add_u32 m0, s92, 139264
    ds_read_b128 v[20:23], v247 offset:4096
    v_cvt_pk_bf16_f32 v71, v110, v111
    v_mfma_f32_16x16x32_bf16 v[24:27], v[116:119], a[72:75], 0
    s_add_u32 s69, s43, 12288
    v_mfma_f32_16x16x32_bf16 v[24:27], v[28:31], a[84:87], v[24:27]
    s_waitcnt lgkmcnt(6)
    v_mfma_f32_16x16x32_bf16 v[24:27], v[40:43], a[96:99], v[24:27]
    s_waitcnt lgkmcnt(4)
    v_cvt_pk_bf16_f32 v122, v16, v17
    v_cvt_pk_bf16_f32 v123, v18, v19
    v_mfma_f32_16x16x32_bf16 v[84:87], v[0:3], v[68:71], 0
    s_waitcnt lgkmcnt(2)
    buffer_load_dwordx4 v32, s[28:31], s70 offen lds
    v_mfma_f32_16x16x32_bf16 v[124:127], v[12:15], v[68:71], 0
    s_waitcnt lgkmcnt(1)
    v_mfma_f32_16x16x32_bf16 v[64:67], v[112:115], v[68:71], 0
    s_waitcnt vmcnt(9)
    v_mfma_f32_16x16x32_bf16 v[108:111], v[204:207], v[68:71], 0
    s_waitcnt lgkmcnt(0)
    v_mfma_f32_16x16x16_bf16 v[84:87], v[4:5], v[122:123], v[84:87]
    v_mfma_f32_16x16x16_bf16 v[124:127], v[6:7], v[122:123], v[124:127]
    buffer_load_dwordx4 v33, s[28:31], s70 offen offset:1024 lds
    v_mfma_f32_16x16x16_bf16 v[64:67], v[120:121], v[122:123], v[64:67]
    s_waitcnt vmcnt(8)
    ds_read_b64_tr_b16 a[120:121], v36 offset:45984
    v_mfma_f32_16x16x16_bf16 v[108:111], v[208:209], v[122:123], v[108:111]
    ds_read_b64_tr_b16 a[122:123], v36 offset:47520
    ds_read_b64_tr_b16 a[124:125], v36 offset:46016
    v_mfma_f32_16x16x32_bf16 v[16:19], v[116:119], a[76:79], 0
    ds_read_b64_tr_b16 a[126:127], v36 offset:47552
    ds_read_b64_tr_b16 a[128:129], v36 offset:46048
    v_mfma_f32_16x16x32_bf16 v[16:19], v[28:31], a[88:91], v[16:19]
    ds_read_b64_tr_b16 a[130:131], v36 offset:47584
    ds_read_b128 v[68:71], v247 offset:5120
    v_mfma_f32_16x16x32_bf16 v[16:19], v[40:43], a[100:103], v[16:19]
    ds_read_b128 v[96:99], v247 offset:6144
    v_max3_f32 v109, v84, v85, v108
    v_mfma_f32_16x16x32_bf16 v[16:19], v[20:23], a[112:115], v[16:19]
    v_max3_f32 v110, v86, v87, v124
    v_max3_f32 v109, v109, v125, v126
    v_mfma_f32_16x16x32_bf16 v[100:103], v[116:119], a[80:83], 0
    ds_read_b128 v[116:119], v247 offset:7168
    v_max3_f32 v110, v110, v127, v64
    v_mfma_f32_16x16x32_bf16 v[100:103], v[28:31], a[92:95], v[100:103]
    s_waitcnt lgkmcnt(8)
    v_max3_f32 v109, v109, v65, v66
    v_max3_f32 v109, v109, v110, v67
    v_mfma_f32_16x16x32_bf16 v[100:103], v[40:43], a[104:107], v[100:103]
    s_waitcnt lgkmcnt(6)
    buffer_load_dwordx4 v34, s[28:31], s70 offen offset:2048 lds
    v_mfma_f32_16x16x32_bf16 v[100:103], v[20:23], a[116:119], v[100:103]
    s_waitcnt lgkmcnt(4)
    ds_read_b128 v[28:31], v247 offset:8192
    s_waitcnt lgkmcnt(3)
    v_mfma_f32_16x16x32_bf16 v[100:103], v[68:71], a[128:131], v[100:103]
    s_add_u32 m0, s92, 33696
    v_mov_b32 v110, v109
    v_cvt_pk_bf16_f32 v122, v104, v105
    v_mfma_f32_16x16x32_bf16 v[40:43], v[0:3], v[8:11], 0
    s_add_u32 s70, s43, 24576
    ds_read_b128 v[132:135], v247 offset:9216
    v_permlane32_swap_b32 v109, v110
    v_mfma_f32_16x16x32_bf16 v[24:27], v[20:23], a[108:111], v[24:27]
    s_waitcnt lgkmcnt(3)
    v_max_f32 v109, v109, v110
    v_mov_b32 v110, v109
    v_mfma_f32_16x16x32_bf16 v[24:27], v[68:71], a[120:123], v[24:27]
    s_waitcnt lgkmcnt(2)
    buffer_load_dwordx4 v32, s[28:31], s71 offen lds
    v_mfma_f32_16x16x32_bf16 v[128:131], v[12:15], v[8:11], 0
    s_waitcnt vmcnt(9)
    v_permlane16_swap_b32 v109, v110
    v_mfma_f32_16x16x32_bf16 v[20:23], v[112:115], v[8:11], 0
    v_max_f32 v109, v109, v110
    v_mul_f32 v109, s44, v109
    v_mfma_f32_16x16x32_bf16 v[16:19], v[68:71], a[124:127], v[16:19]
    s_waitcnt lgkmcnt(1)
    v_fma_f32 v84, v84, s44, -v109
    v_cvt_pk_bf16_f32 v123, v106, v107
    v_mfma_f32_16x16x32_bf16 v[68:71], v[204:207], v[8:11], 0
    v_fma_f32 v85, v85, s44, -v109
    v_fma_f32 v86, v86, s44, -v109
    v_mfma_f32_16x16x16_bf16 v[40:43], v[4:5], v[122:123], v[40:43]
    s_waitcnt lgkmcnt(0)
    buffer_load_dwordx4 v33, s[28:31], s71 offen offset:1024 lds
    v_mfma_f32_16x16x16_bf16 v[128:131], v[6:7], v[122:123], v[128:131]
    s_waitcnt vmcnt(9)
    s_waitcnt vmcnt(8)
    ds_read_b64_tr_b16 a[132:133], v37 offset:61440
    v_mfma_f32_16x16x16_bf16 v[20:23], v[120:121], v[122:123], v[20:23]
    ds_read_b64_tr_b16 a[134:135], v37 offset:62976
    ds_read_b64_tr_b16 a[136:137], v37 offset:61472
    v_mfma_f32_16x16x16_bf16 v[68:71], v[208:209], v[122:123], v[68:71]
    ds_read_b64_tr_b16 a[138:139], v37 offset:63008
    ds_read_b64_tr_b16 a[140:141], v37 offset:61504
    v_mfma_f32_16x16x32_bf16 v[104:107], v[116:119], a[72:75], 0
    ds_read_b64_tr_b16 a[142:143], v37 offset:63040
    v_fma_f32 v87, v87, s44, -v109
    v_mfma_f32_16x16x32_bf16 v[104:107], v[28:31], a[84:87], v[104:107]
    buffer_load_dwordx4 v34, s[28:31], s71 offen offset:2048 lds
    v_mfma_f32_16x16x32_bf16 v[104:107], v[132:135], a[96:99], v[104:107]
    s_add_u32 m0, s92, 45984
    ds_read_b128 v[8:11], v247 offset:10240
    v_fma_f32 v124, v124, s44, -v109
    v_fma_f32 v125, v125, s44, -v109
    v_fma_f32 v126, v126, s44, -v109
    v_fma_f32 v127, v127, s44, -v109
    s_waitcnt lgkmcnt(5)
    v_mfma_f32_16x16x32_bf16 v[24:27], v[96:99], a[132:135], v[24:27]
    s_add_u32 s71, s43, 49152
    s_waitcnt lgkmcnt(3)
    v_fma_f32 v64, v64, s44, -v109
    v_mfma_f32_16x16x32_bf16 v[16:19], v[96:99], a[136:139], v[16:19]
    s_waitcnt lgkmcnt(1)
    v_fma_f32 v65, v65, s44, -v109
    v_mfma_f32_16x16x32_bf16 v[100:103], v[96:99], a[140:143], v[100:103]
    buffer_load_dwordx4 v32, s[28:31], s68 offen lds
    v_mfma_f32_16x16x32_bf16 v[96:99], v[116:119], a[76:79], 0
    s_waitcnt vmcnt(9)
    v_fma_f32 v66, v66, s44, -v109
    v_fma_f32 v67, v67, s44, -v109
    v_mfma_f32_16x16x32_bf16 v[96:99], v[28:31], a[88:91], v[96:99]
    v_fma_f32 v108, v108, s44, -v109
    v_exp_f32 v84, v84
    v_mfma_f32_16x16x32_bf16 v[96:99], v[132:135], a[100:103], v[96:99]
    s_waitcnt lgkmcnt(0)
    v_exp_f32 v85, v85
    v_mfma_f32_16x16x32_bf16 v[96:99], v[8:11], a[112:115], v[96:99]
    s_waitcnt vmcnt(7)
    ds_read_b64_tr_b16 a[216:217], v37 offset:36864
    v_mfma_f32_16x16x32_bf16 v[104:107], v[8:11], a[108:111], v[104:107]
    buffer_load_dwordx4 v33, s[28:31], s68 offen offset:1024 lds
    ds_read_b64_tr_b16 a[218:219], v37 offset:38400
    ds_read_b64_tr_b16 a[220:221], v37 offset:36896
    ds_read_b64_tr_b16 a[222:223], v37 offset:38432
    ds_read_b64_tr_b16 a[224:225], v37 offset:36928
    ds_read_b64_tr_b16 a[226:227], v37 offset:38464
    v_exp_f32 v86, v86
    v_exp_f32 v87, v87
    v_exp_f32 v124, v124
    v_exp_f32 v125, v125
    v_exp_f32 v126, v126
    v_exp_f32 v127, v127
    buffer_load_dwordx4 v34, s[28:31], s68 offen offset:2048 lds
    s_add_u32 m0, s92, 151552
    s_add_u32 s68, s43, 61440
    v_exp_f32 v64, v64
    v_exp_f32 v65, v65
    v_exp_f32 v66, v66
    v_exp_f32 v67, v67
    v_exp_f32 v108, v108
    v_cvt_pk_bf16_f32 v84, v84, v85
    v_cvt_pk_bf16_f32 v85, v86, v87
    v_cvt_pk_bf16_f32 v86, v124, v125
    v_cvt_pk_bf16_f32 v87, v126, v127
    v_mfma_f32_16x16x32_bf16 v[124:127], v[116:119], a[80:83], 0
    s_waitcnt lgkmcnt(0)
    buffer_load_dwordx4 v32, s[28:31], s69 offen lds
    v_mfma_f32_16x16x32_bf16 v[124:127], v[28:31], a[92:95], v[124:127]
    s_waitcnt vmcnt(9)
    ds_read_b128 v[116:119], v247 offset:11264
    ds_read_b128 v[28:31], v247 offset:12288
    v_mfma_f32_16x16x32_bf16 v[124:127], v[132:135], a[104:107], v[124:127]
    ds_read_b128 v[132:135], v247 offset:13312
    v_cvt_pk_bf16_f32 v64, v64, v65
    v_mfma_f32_16x16x32_bf16 v[124:127], v[8:11], a[116:119], v[124:127]
    ds_read_b128 v[8:11], v247 offset:14336
    v_cvt_pk_bf16_f32 v65, v66, v67
    v_cvt_pk_bf16_f32 v66, v108, 0
    ds_read_b128 v[108:111], v247 offset:15360
    v_mov_b32 v67, 0
    v_cvt_pk_bf16_f32 v24, v24, v25
    v_cvt_pk_bf16_f32 v25, v26, v27
    v_cvt_pk_bf16_f32 v16, v16, v17
    v_cvt_pk_bf16_f32 v17, v18, v19
    v_cvt_pk_bf16_f32 v100, v100, v101
    v_cvt_pk_bf16_f32 v101, v102, v103
    v_max3_f32 v69, v40, v41, v68
    v_max3_f32 v70, v42, v43, v128
    s_waitcnt lgkmcnt(4)
    v_mfma_f32_16x16x32_bf16 v[124:127], v[116:119], a[128:131], v[124:127]
    s_waitcnt vmcnt(8)
    s_waitcnt lgkmcnt(3)
    v_max3_f32 v69, v69, v129, v130
    v_mfma_f32_16x16x32_bf16 v[124:127], v[28:31], a[140:143], v[124:127]
    buffer_load_dwordx4 v35, s[28:31], s69 offen offset:1024 lds
    v_mfma_f32_16x16x32_bf16 v[104:107], v[116:119], a[120:123], v[104:107]
    s_add_u32 s69, s39, 1118208
    s_waitcnt vmcnt(8)
    ds_read_b64_tr_b16 a[228:229], v37 offset:49152
    v_mfma_f32_16x16x32_bf16 v[104:107], v[28:31], a[132:135], v[104:107]
    s_waitcnt lgkmcnt(3)
    ds_read_b64_tr_b16 a[230:231], v37 offset:50688
    ds_read_b64_tr_b16 a[232:233], v37 offset:49184
    v_mfma_f32_16x16x32_bf16 v[96:99], v[116:119], a[124:127], v[96:99]
    s_waitcnt lgkmcnt(4)
    ds_read_b64_tr_b16 a[234:235], v37 offset:50720
    ds_read_b64_tr_b16 a[236:237], v37 offset:49216
    v_mfma_f32_16x16x32_bf16 v[96:99], v[28:31], a[136:139], v[96:99]
    s_waitcnt lgkmcnt(5)
    ds_read_b64_tr_b16 a[238:239], v37 offset:50752
    ds_read_b128 v[116:119], v247 offset:16384
    v_mfma_f32_16x16x32_bf16 v[28:31], a[144:147], v[132:135], 0
    buffer_load_dwordx4 v34, s[28:31], s70 offen offset:2048 lds
    v_mfma_f32_16x16x32_bf16 v[28:31], a[156:159], v[8:11], v[28:31]
    s_add_u32 m0, s92, 126976
    v_cvt_pk_bf16_f32 v26, v104, v105
    v_cvt_pk_bf16_f32 v27, v106, v107
    v_mfma_f32_16x16x32_bf16 v[28:31], a[168:171], v[108:111], v[28:31]
    s_add_u32 s70, s39, 1204224
    ds_read_b128 v[104:107], v247 offset:17408
    v_cvt_pk_bf16_f32 v18, v96, v97
    v_cvt_pk_bf16_f32 v19, v98, v99
    v_mfma_f32_16x16x32_bf16 v[96:99], a[148:151], v[132:135], 0
    s_waitcnt lgkmcnt(6)
    v_cvt_pk_bf16_f32 v102, v124, v125
    v_cvt_pk_bf16_f32 v103, v126, v127
    v_mfma_f32_16x16x32_bf16 v[96:99], a[160:163], v[8:11], v[96:99]
    s_waitcnt lgkmcnt(4)
    ds_read_b128 v[124:127], v247 offset:18432
    v_max3_f32 v70, v70, v131, v20
    v_mfma_f32_16x16x32_bf16 v[96:99], a[172:175], v[108:111], v[96:99]
    s_waitcnt lgkmcnt(3)
    buffer_load_dwordx4 v32, s[28:31], s71 offen lds
    s_waitcnt lgkmcnt(2)
    v_mfma_f32_16x16x32_bf16 v[96:99], a[184:187], v[116:119], v[96:99]
    s_waitcnt vmcnt(9)
    v_max3_f32 v69, v69, v21, v22
    v_max3_f32 v69, v69, v70, v23
    v_mfma_f32_16x16x32_bf16 v[28:31], a[180:183], v[116:119], v[28:31]
    s_lshl_b32 s41, s36, 8
    s_waitcnt lgkmcnt(1)
    v_mov_b32 v70, v69
    v_mfma_f32_16x16x32_bf16 v[28:31], a[192:195], v[104:107], v[28:31]
    s_add_u32 s41, s41, 64512
    v_permlane32_swap_b32 v69, v70
    v_mfma_f32_16x16x32_bf16 v[96:99], a[196:199], v[104:107], v[96:99]
    s_waitcnt lgkmcnt(0)
    buffer_load_dwordx4 v35, s[28:31], s71 offen offset:1024 lds
    v_mfma_f32_16x16x32_bf16 v[96:99], a[208:211], v[124:127], v[96:99]
    s_add_u32 s71, s39, 1290240
    s_waitcnt vmcnt(8)
    ds_read_b64_tr_b16 a[240:241], v36 offset:33696
    v_mfma_f32_16x16x32_bf16 v[28:31], a[204:207], v[124:127], v[28:31]
    ds_read_b64_tr_b16 a[242:243], v36 offset:35232
    ds_read_b64_tr_b16 a[244:245], v36 offset:33728
    ds_read_b64_tr_b16 a[246:247], v36 offset:35264
    ds_read_b64_tr_b16 a[248:249], v36 offset:33760
    ds_read_b64_tr_b16 a[250:251], v36 offset:35296
    v_max_f32 v69, v69, v70
    v_mov_b32 v70, v69
    s_nop 0
    v_cvt_pk_bf16_f32 v28, v28, v29
    v_cvt_pk_bf16_f32 v29, v30, v31
    buffer_load_dwordx4 v34, s[28:31], s68 offen offset:2048 lds
    v_mfma_f32_16x16x32_bf16 v[32:35], a[152:155], v[132:135], 0
    s_add_u32 m0, s40, 0
    v_cvt_pk_bf16_f32 v30, v96, v97
    v_cvt_pk_bf16_f32 v31, v98, v99
    v_mfma_f32_16x16x32_bf16 v[32:35], a[164:167], v[8:11], v[32:35]
    s_waitcnt lgkmcnt(5)
    v_permlane16_swap_b32 v69, v70
    v_mfma_f32_16x16x32_bf16 v[32:35], a[176:179], v[108:111], v[32:35]
    s_waitcnt lgkmcnt(4)
    v_max_f32 v69, v69, v70
    v_mul_f32 v69, s44, v69
    v_mfma_f32_16x16x32_bf16 v[32:35], a[188:191], v[116:119], v[32:35]
    s_waitcnt lgkmcnt(2)
    v_fma_f32 v40, v40, s44, -v69
    v_fma_f32 v41, v41, s44, -v69
    v_mfma_f32_16x16x32_bf16 v[32:35], a[200:203], v[104:107], v[32:35]
    s_waitcnt lgkmcnt(0)
    buffer_load_dwordx4 v252, s[16:19], s69 offen nt lds
    v_mfma_f32_16x16x32_bf16 v[32:35], a[212:215], v[124:127], v[32:35]
    s_waitcnt vmcnt(9)
    v_fma_f32 v42, v42, s44, -v69
    v_fma_f32 v43, v43, s44, -v69
    v_mfma_f32_16x16x32_bf16 v[96:99], v[0:3], v[28:31], 0
    s_add_u32 m0, s40, 3744
    s_add_u32 s68, s39, 1376256
    s_add_u32 s69, s39, 1462272
    v_fma_f32 v128, v128, s44, -v69
    v_fma_f32 v129, v129, s44, -v69
    v_fma_f32 v130, v130, s44, -v69
    v_cvt_pk_bf16_f32 v122, v32, v33
    v_cvt_pk_bf16_f32 v123, v34, v35
    v_mfma_f32_16x16x32_bf16 v[32:35], v[132:135], a[72:75], 0
    buffer_load_dwordx4 v252, s[16:19], s70 offen nt lds
    v_mfma_f32_16x16x32_bf16 v[32:35], v[8:11], a[84:87], v[32:35]
    s_add_u32 m0, s40, 7488
    s_waitcnt vmcnt(8)
    ds_read_b64_tr_b16 a[252:253], v36 offset:45984
    v_mfma_f32_16x16x32_bf16 v[32:35], v[108:111], a[96:99], v[32:35]
    s_add_u32 s70, s39, 1548288
    ds_read_b64_tr_b16 a[254:255], v36 offset:47520
    ds_read_b64_tr_b16 v[172:173], v36 offset:46016
    v_mfma_f32_16x16x32_bf16 v[32:35], v[116:119], a[108:111], v[32:35]
    ds_read_b64_tr_b16 v[174:175], v36 offset:47552
    ds_read_b64_tr_b16 v[176:177], v36 offset:46048
    v_mfma_f32_16x16x32_bf16 v[32:35], v[104:107], a[120:123], v[32:35]
    ds_read_b64_tr_b16 v[178:179], v36 offset:47584
    buffer_load_dwordx4 v252, s[16:19], s71 offen nt lds
    v_mfma_f32_16x16x32_bf16 v[32:35], v[124:127], a[132:135], v[32:35]
    s_add_u32 m0, s40, 11232
    v_fma_f32 v131, v131, s44, -v69
    v_fma_f32 v20, v20, s44, -v69
    v_mfma_f32_16x16x16_bf16 v[96:99], v[4:5], v[122:123], v[96:99]
    s_add_u32 s71, s39, 1634304
    v_fma_f32 v21, v21, s44, -v69
    v_fma_f32 v22, v22, s44, -v69
    v_fma_f32 v23, v23, s44, -v69
    v_fma_f32 v68, v68, s44, -v69
    v_exp_f32 v40, v40
    v_cvt_pk_bf16_f32 v216, v32, v33
    v_cvt_pk_bf16_f32 v217, v34, v35
    v_mfma_f32_16x16x32_bf16 v[32:35], v[132:135], a[76:79], 0
    s_waitcnt lgkmcnt(3)
    buffer_load_dwordx4 v252, s[16:19], s68 offen nt lds
    v_mfma_f32_16x16x32_bf16 v[32:35], v[8:11], a[88:91], v[32:35]
    s_waitcnt lgkmcnt(1)
    v_exp_f32 v41, v41
    v_mfma_f32_16x16x32_bf16 v[32:35], v[108:111], a[100:103], v[32:35]
    s_waitcnt lgkmcnt(0)
    v_exp_f32 v42, v42
    v_mfma_f32_16x16x32_bf16 v[32:35], v[116:119], a[112:115], v[32:35]
    s_add_u32 m0, s40, 14976
    v_exp_f32 v43, v43
    v_mfma_f32_16x16x32_bf16 v[32:35], v[104:107], a[124:127], v[32:35]
    s_waitcnt vmcnt(9)
    v_exp_f32 v128, v128
    v_mfma_f32_16x16x32_bf16 v[32:35], v[124:127], a[136:139], v[32:35]
    s_add_u32 s68, s39, 1720320
    buffer_load_dwordx4 v252, s[16:19], s69 offen nt lds
    s_add_u32 m0, s40, 18720
    s_add_u32 s69, s39, 1806336
    v_exp_f32 v129, v129
    v_exp_f32 v130, v130
    v_exp_f32 v131, v131
    v_exp_f32 v20, v20
    v_cvt_pk_bf16_f32 v220, v32, v33
    v_cvt_pk_bf16_f32 v221, v34, v35
    v_mfma_f32_16x16x32_bf16 v[32:35], v[132:135], a[80:83], 0
    v_exp_f32 v21, v21
    v_mfma_f32_16x16x32_bf16 v[32:35], v[8:11], a[92:95], v[32:35]
    buffer_load_dwordx4 v252, s[16:19], s70 offen nt lds
    v_mfma_f32_16x16x32_bf16 v[32:35], v[108:111], a[104:107], v[32:35]
    s_add_u32 m0, s40, 22464
    s_waitcnt vmcnt(9)
    ds_read_b64_tr_b16 v[180:181], v37 offset:61440
    v_mfma_f32_16x16x32_bf16 v[32:35], v[116:119], a[116:119], v[32:35]
    s_add_u32 s70, s39, 1892352
    ds_read_b64_tr_b16 v[182:183], v37 offset:62976
    ds_read_b64_tr_b16 v[184:185], v37 offset:61472
    v_mfma_f32_16x16x32_bf16 v[32:35], v[104:107], a[128:131], v[32:35]
    ds_read_b64_tr_b16 v[186:187], v37 offset:63008
    ds_read_b64_tr_b16 v[188:189], v37 offset:61504
    v_mfma_f32_16x16x32_bf16 v[32:35], v[124:127], a[140:143], v[32:35]
    ds_read_b64_tr_b16 v[190:191], v37 offset:63040
    buffer_load_dwordx4 v252, s[16:19], s71 offen nt lds
    v_mfma_f32_16x16x32_bf16 v[132:135], v[12:15], v[28:31], 0
    s_add_u32 m0, s40, 26208
    ds_read_b128 v[8:11], v38 offset:0
    ds_read_b128 v[116:119], v38 offset:256
    ds_read_b128 v[124:127], v38 offset:512
    v_exp_f32 v22, v22
    v_cvt_pk_bf16_f32 v224, v32, v33
    v_cvt_pk_bf16_f32 v225, v34, v35
    v_mfma_f32_16x16x16_bf16 v[132:135], v[6:7], v[122:123], v[132:135]
    s_waitcnt lgkmcnt(8)
    s_add_u32 s71, s39, 1978368
    v_exp_f32 v23, v23
    v_exp_f32 v68, v68
    buffer_load_dwordx4 v252, s[16:19], s68 offen nt lds
    v_cvt_pk_bf16_f32 v40, v40, v41
    v_cvt_pk_bf16_f32 v41, v42, v43
    v_cvt_pk_bf16_f32 v42, v128, v129
    v_cvt_pk_bf16_f32 v43, v130, v131
    v_mfma_f32_16x16x32_bf16 v[32:35], v[112:115], v[28:31], 0
    s_waitcnt lgkmcnt(3)
    s_waitcnt lgkmcnt(2)
    v_cvt_pk_bf16_f32 v20, v20, v21
    v_mfma_f32_16x16x32_bf16 v[128:131], v[8:11], a[72:75], 0
    s_waitcnt vmcnt(10)
    s_waitcnt lgkmcnt(1)
    v_cvt_pk_bf16_f32 v21, v22, v23
    v_mfma_f32_16x16x32_bf16 v[128:131], v[116:119], a[84:87], v[128:131]
    s_add_u32 m0, s40, 29952
    s_waitcnt lgkmcnt(0)
    buffer_load_dwordx4 v252, s[16:19], s69 offen nt lds
    v_mfma_f32_16x16x32_bf16 v[128:131], v[124:127], a[96:99], v[128:131]
    s_add_u32 m0, s40, 33696
    v_cvt_pk_bf16_f32 v22, v68, 0
    v_mov_b32 v23, 0
    v_mfma_f32_16x16x32_bf16 v[68:71], v[204:207], v[28:31], 0
    s_add_u32 s68, s39, 2064384
    ds_read_b128 v[28:31], v38 offset:768
    s_waitcnt vmcnt(9)
    ds_read_b64_tr_b16 v[192:193], v37 offset:36864
    v_mfma_f32_16x16x16_bf16 v[32:35], v[120:121], v[122:123], v[32:35]
    s_add_u32 s69, s39, 2150400
    ds_read_b64_tr_b16 v[194:195], v37 offset:38400
    ds_read_b64_tr_b16 v[196:197], v37 offset:36896
    v_mfma_f32_16x16x16_bf16 v[68:71], v[208:209], v[122:123], v[68:71]
    ds_read_b64_tr_b16 v[198:199], v37 offset:38432
    ds_read_b64_tr_b16 v[200:201], v37 offset:36928
    v_mfma_f32_16x16x32_bf16 v[108:111], v[8:11], a[76:79], 0
    ds_read_b64_tr_b16 v[202:203], v37 offset:38464
    v_mfma_f32_16x16x32_bf16 v[108:111], v[116:119], a[88:91], v[108:111]
    v_mfma_f32_16x16x32_bf16 v[108:111], v[124:127], a[100:103], v[108:111]
    s_waitcnt lgkmcnt(6)
    v_mfma_f32_16x16x32_bf16 v[108:111], v[28:31], a[112:115], v[108:111]
    v_max3_f32 v69, v96, v97, v68
    v_max3_f32 v70, v98, v99, v132
    v_mfma_f32_16x16x32_bf16 v[104:107], v[8:11], a[80:83], 0
    s_waitcnt lgkmcnt(5)
    ds_read_b128 v[8:11], v38 offset:1024
    v_max3_f32 v69, v69, v133, v134
    v_mfma_f32_16x16x32_bf16 v[104:107], v[116:119], a[92:95], v[104:107]
    s_waitcnt lgkmcnt(4)
    ds_read_b128 v[116:119], v38 offset:1280
    v_max3_f32 v70, v70, v135, v32
    v_mfma_f32_16x16x32_bf16 v[104:107], v[124:127], a[104:107], v[104:107]
    s_waitcnt lgkmcnt(3)
    v_max3_f32 v69, v69, v33, v34
    v_max3_f32 v69, v69, v70, v35
    v_mfma_f32_16x16x32_bf16 v[104:107], v[28:31], a[116:119], v[104:107]
    s_waitcnt lgkmcnt(2)
    v_mov_b32 v70, v69
    v_mfma_f32_16x16x32_bf16 v[128:131], v[28:31], a[108:111], v[128:131]
    v_mfma_f32_16x16x32_bf16 v[36:39], v[228:231], v[84:87], 0
    v_permlane32_swap_b32 v69, v70
    v_mfma_f32_16x16x32_bf16 v[36:39], v[230:233], v[64:67], v[36:39]
    s_waitcnt lgkmcnt(1)
    v_max_f32 v69, v69, v70
    v_mfma_f32_16x16x32_bf16 v[128:131], v[8:11], a[120:123], v[128:131]
    s_waitcnt lgkmcnt(0)
    v_mov_b32 v70, v69
    v_mfma_f32_16x16x32_bf16 v[128:131], v[116:119], a[132:135], v[128:131]
    v_mfma_f32_16x16x32_bf16 v[108:111], v[8:11], a[124:127], v[108:111]
    v_permlane16_swap_b32 v69, v70
    v_mfma_f32_16x16x32_bf16 v[108:111], v[116:119], a[136:139], v[108:111]
    v_rcp_f32 v36, v36
    v_mfma_f32_16x16x32_bf16 v[104:107], v[8:11], a[128:131], v[104:107]
    v_max_f32 v69, v69, v70
    v_mul_f32 v69, s44, v69
    v_mfma_f32_16x16x32_bf16 v[104:107], v[116:119], a[140:143], v[104:107]
    v_cvt_pk_bf16_f32 v218, v128, v129
    v_cndmask_b32 v218, 0, v218, vcc
    v_mfma_f32_16x16x32_bf16 v[124:127], v[24:27], v[84:87], 0
    v_cvt_pk_bf16_f32 v219, v130, v131
    v_cndmask_b32 v219, 0, v219, vcc
    v_mfma_f32_16x16x32_bf16 v[28:31], v[16:19], v[84:87], 0
    v_cvt_pk_bf16_f32 v222, v108, v109
    v_cndmask_b32 v222, 0, v222, vcc
    v_mfma_f32_16x16x32_bf16 v[8:11], v[100:103], v[84:87], 0
    v_cvt_pk_bf16_f32 v223, v110, v111
    v_cndmask_b32 v223, 0, v223, vcc
    v_mfma_f32_16x16x32_bf16 v[124:127], v[216:219], v[64:67], v[124:127]
    v_cvt_pk_bf16_f32 v226, v104, v105
    v_cndmask_b32 v226, 0, v226, vcc
    v_mfma_f32_16x16x32_bf16 v[28:31], v[220:223], v[64:67], v[28:31]
    v_cvt_pk_bf16_f32 v227, v106, v107
    v_cndmask_b32 v227, 0, v227, vcc
    v_mfma_f32_16x16x32_bf16 v[116:119], v[228:231], v[40:43], 0
    s_mov_b32 vcc_lo, 0
    v_fma_f32 v96, v96, s44, -v69
    v_mul_f32 v124, v124, v36
    v_mfma_f32_16x16x32_bf16 v[116:119], v[230:233], v[20:23], v[116:119]
    s_mov_b32 vcc_hi, 0x10000
    v_mul_f32 v125, v125, v36
    v_mul_f32 v126, v126, v36
    v_mfma_f32_16x16x32_bf16 v[8:11], v[224:227], v[64:67], v[8:11]
    v_mul_f32 v127, v127, v36
    v_mul_f32 v28, v28, v36
    v_mfma_f32_16x16x32_bf16 v[128:131], v[24:27], v[40:43], 0
    v_mul_f32 v29, v29, v36
    v_mul_f32 v30, v30, v36
    v_mfma_f32_16x16x32_bf16 v[128:131], v[216:219], v[20:23], v[128:131]
    v_mul_f32 v31, v31, v36
    v_cvt_pk_bf16_f32 v124, v124, v125
    v_mfma_f32_16x16x32_bf16 v[84:87], v[16:19], v[40:43], 0
    v_mul_f32 v8, v8, v36
    v_mul_f32 v9, v9, v36
    v_mfma_f32_16x16x32_bf16 v[84:87], v[220:223], v[20:23], v[84:87]
    v_mul_f32 v10, v10, v36
    v_mul_f32 v11, v11, v36
    v_mfma_f32_16x16x32_bf16 v[64:67], v[100:103], v[40:43], 0
    v_cvt_pk_bf16_f32 v125, v126, v127
    v_cvt_pk_bf16_f32 v126, v28, v29
    v_mfma_f32_16x16x32_bf16 v[64:67], v[224:227], v[20:23], v[64:67]
    v_cvt_pk_bf16_f32 v127, v30, v31
    v_cvt_pk_bf16_f32 v8, v8, v9
    v_mfma_f32_16x16x32_bf16 v[36:39], v[210:213], v[0:3], 0
    ds_write_b128 v245, v[124:127] offset:44032
    v_mfma_f32_16x16x32_bf16 v[40:43], v[210:213], v[12:15], 0
    v_cvt_pk_bf16_f32 v9, v10, v11
    v_rcp_f32 v116, v116
    v_mfma_f32_16x16x16_bf16 v[20:23], v[234:235], v[56:57], 0
    v_mul_f32 v128, v128, v116
    v_mul_f32 v129, v129, v116
    v_mfma_f32_16x16x32_bf16 v[28:31], v[210:213], v[112:115], 0
    ds_write_b64 v246, v[8:9] offset:44032
    v_mfma_f32_16x16x16_bf16 v[0:3], v[234:235], v[58:59], 0
    v_mul_f32 v130, v130, v116
    v_mul_f32 v131, v131, v116
    v_mfma_f32_16x16x32_bf16 v[124:127], v[210:213], v[204:207], 0
    v_mul_f32 v84, v84, v116
    v_mul_f32 v85, v85, v116
    v_mfma_f32_16x16x16_bf16 v[112:115], v[234:235], v[76:77], 0
    v_mul_f32 v86, v86, v116
    v_mul_f32 v87, v87, v116
    v_mfma_f32_16x16x16_bf16 v[36:39], v[214:215], v[4:5], v[36:39]
    v_mul_f32 v64, v64, v116
    v_mul_f32 v65, v65, v116
    v_mfma_f32_16x16x16_bf16 v[56:59], v[234:235], v[92:93], 0
    v_mul_f32 v66, v66, v116
    v_mul_f32 v67, v67, v116
    v_mfma_f32_16x16x16_bf16 v[40:43], v[214:215], v[6:7], v[40:43]
    v_cvt_pk_bf16_f32 v128, v128, v129
    v_cvt_pk_bf16_f32 v129, v130, v131
    v_mfma_f32_16x16x16_bf16 v[116:119], v[234:235], v[94:95], 0
    v_cvt_pk_bf16_f32 v130, v84, v85
    v_cvt_pk_bf16_f32 v131, v86, v87
    v_mfma_f32_16x16x16_bf16 v[28:31], v[214:215], v[120:121], v[28:31]
    ds_write_b128 v245, v[128:131] offset:50176
    v_mfma_f32_16x16x16_bf16 v[4:7], v[234:235], v[78:79], 0
    v_cvt_pk_bf16_f32 v64, v64, v65
    v_cvt_pk_bf16_f32 v65, v66, v67
    v_mfma_f32_16x16x16_bf16 v[124:127], v[214:215], v[208:209], v[124:127]
    v_fma_f32 v97, v97, s44, -v69
    v_fma_f32 v98, v98, s44, -v69
    v_mfma_f32_16x16x16_bf16 v[92:95], v[234:235], v[60:61], 0
    ds_write_b64 v246, v[64:65] offset:50176
    v_mfma_f32_16x16x16_bf16 v[84:87], v[234:235], v[62:63], 0
    v_fma_f32 v99, v99, s44, -v69
    v_fma_f32 v132, v132, s44, -v69
    v_mfma_f32_16x16x16_bf16 v[120:123], v[234:235], v[88:89], 0
    v_mov_b32 v125, 0xff800000
    v_cndmask_b32 v124, v125, v124, vcc
    v_fma_f32 v133, v133, s44, -v69
    v_fma_f32 v134, v134, s44, -v69
    v_mov_b32_dpp v124, v36 quad_perm:[0,1,2,3] row_mask:0x1 bank_mask:0xf
    v_fma_f32 v135, v135, s44, -v69
    v_fma_f32 v32, v32, s44, -v69
    v_mov_b32_dpp v124, v40 quad_perm:[0,1,2,3] row_mask:0x2 bank_mask:0xf
    v_fma_f32 v33, v33, s44, -v69
    v_fma_f32 v34, v34, s44, -v69
    v_mov_b32_dpp v124, v28 quad_perm:[0,1,2,3] row_mask:0x4 bank_mask:0xf
    v_mul_f32 v124, s44, v124
    v_fma_f32 v35, v35, s44, -v69
    v_fma_f32 v68, v68, s44, -v69
    s_waitcnt lgkmcnt(0)
    s_barrier
    v_max_f32_dpp v125, v124, v124 row_ror:8 row_mask:0xf bank_mask:0xf
    v_exp_f32 v96, v96
    v_exp_f32 v97, v97
    ds_read_b128 v[128:131], v247 offset:50176
    buffer_load_dwordx4 v252, s[16:19], s70 offen nt lds
    ds_read_b128 v[76:79], v247 offset:51200
    ds_read_b128 v[64:67], v247 offset:52224
    ds_read_b128 v[60:63], v247 offset:53248
    s_add_u32 m0, s40, 37440
    s_add_u32 s70, s39, 2236416
    v_max_f32_dpp v125, v125, v125 row_ror:4 row_mask:0xf bank_mask:0xf
    v_exp_f32 v98, v98
    v_exp_f32 v99, v99
    v_max_f32_dpp v125, v125, v125 row_ror:2 row_mask:0xf bank_mask:0xf
    v_exp_f32 v132, v132
    v_exp_f32 v133, v133
    v_max_f32_dpp v125, v125, v125 row_ror:1 row_mask:0xf bank_mask:0xf
    v_exp_f32 v134, v134
    v_exp_f32 v135, v135
    s_waitcnt lgkmcnt(3)
    v_mfma_f32_16x16x32_bf16 v[56:59], a[216:219], v[128:131], v[56:59]
    buffer_load_dwordx4 v252, s[16:19], s71 offen nt lds
    s_waitcnt lgkmcnt(2)
    v_mfma_f32_16x16x32_bf16 v[56:59], a[228:231], v[76:79], v[56:59]
    s_add_u32 m0, s40, 41184
    ds_read_b128 v[88:91], v247 offset:54272
    s_waitcnt lgkmcnt(2)
    v_mfma_f32_16x16x32_bf16 v[56:59], a[240:243], v[64:67], v[56:59]
    s_add_u32 s71, s39, 2322432
    s_waitcnt lgkmcnt(1)
    v_max_f32_dpp v125, v125, v125 row_bcast:15 row_mask:0xa bank_mask:0xf
    v_mfma_f32_16x16x32_bf16 v[56:59], a[252:255], v[60:63], v[56:59]
    v_exp_f32 v32, v32
    v_mfma_f32_16x16x32_bf16 v[116:119], a[220:223], v[128:131], v[116:119]
    buffer_load_dwordx4 v252, s[16:19], s68 offen nt lds
    v_mfma_f32_16x16x32_bf16 v[116:119], a[232:235], v[76:79], v[116:119]
    s_add_u32 m0, s40, 44928
    ds_read_b128 v[36:39], v247 offset:44032
    v_max_f32_dpp v125, v125, v125 row_bcast:31 row_mask:0xc bank_mask:0xf
    v_mfma_f32_16x16x32_bf16 v[116:119], a[244:247], v[64:67], v[116:119]
    s_add_u32 s68, s39, 2408448
    ds_read_b128 v[40:43], v247 offset:55296
    v_readlane_b32 s85, v125, 63
    v_mfma_f32_16x16x32_bf16 v[116:119], v[172:175], v[60:63], v[116:119]
    s_waitcnt lgkmcnt(2)
    v_subrev_f32 v124, s85, v124
    v_mfma_f32_16x16x32_bf16 v[116:119], v[184:187], v[88:91], v[116:119]
    v_exp_f32 v124, v124
    v_mfma_f32_16x16x32_bf16 v[4:7], a[224:227], v[128:131], v[4:7]
    v_exp_f32 v33, v33
    v_mfma_f32_16x16x32_bf16 v[4:7], a[236:239], v[76:79], v[4:7]
    ds_read_b128 v[28:31], v247 offset:45056
    v_add_f32_dpp v125, v124, v124 row_ror:8 row_mask:0xf bank_mask:0xf
    v_mfma_f32_16x16x32_bf16 v[4:7], a[248:251], v[64:67], v[4:7]
    v_exp_f32 v34, v34
    v_mfma_f32_16x16x32_bf16 v[4:7], v[176:179], v[60:63], v[4:7]
    s_waitcnt lgkmcnt(2)
    v_add_f32_dpp v125, v125, v125 row_ror:4 row_mask:0xf bank_mask:0xf
    v_exp_f32 v35, v35
    v_mfma_f32_16x16x32_bf16 v[4:7], v[188:191], v[88:91], v[4:7]
    s_waitcnt lgkmcnt(1)
    ds_read_b128 v[128:131], v247 offset:46080
    v_add_f32_dpp v125, v125, v125 row_ror:2 row_mask:0xf bank_mask:0xf
    v_mfma_f32_16x16x32_bf16 v[4:7], v[200:203], v[40:43], v[4:7]
    v_exp_f32 v68, v68
    v_mfma_f32_16x16x32_bf16 v[56:59], v[180:183], v[88:91], v[56:59]
    v_add_f32_dpp v125, v125, v125 row_ror:1 row_mask:0xf bank_mask:0xf
    v_cvt_pk_bf16_f32 v96, v96, v97
    v_mfma_f32_16x16x32_bf16 v[56:59], v[192:195], v[40:43], v[56:59]
    ds_read_b128 v[76:79], v247 offset:47104
    v_add_f32_dpp v125, v125, v125 row_bcast:15 row_mask:0xa bank_mask:0xf
    v_mfma_f32_16x16x32_bf16 v[20:23], a[216:219], v[36:39], v[20:23]
    s_waitcnt lgkmcnt(2)
    v_cvt_pk_bf16_f32 v4, v4, v5
    v_cvt_pk_bf16_f32 v5, v6, v7
    v_mfma_f32_16x16x32_bf16 v[20:23], a[228:231], v[28:31], v[20:23]
    v_add_f32_dpp v125, v125, v125 row_bcast:31 row_mask:0xc bank_mask:0xf
    v_cvt_pk_bf16_f32 v56, v56, v57
    v_mfma_f32_16x16x32_bf16 v[0:3], a[220:223], v[36:39], v[0:3]
    ds_read_b128 v[64:67], v247 offset:48128
    v_cvt_pk_bf16_f32 v57, v58, v59
    v_mfma_f32_16x16x32_bf16 v[0:3], a[232:235], v[28:31], v[0:3]
    s_waitcnt lgkmcnt(2)
    ds_write_b64 v243, v[56:57] offset:0
    v_mfma_f32_16x16x32_bf16 v[0:3], a[244:247], v[128:131], v[0:3]
    buffer_load_dwordx4 v252, s[16:19], s69 offen nt lds
    s_waitcnt lgkmcnt(2)
    v_mfma_f32_16x16x32_bf16 v[0:3], v[172:175], v[76:79], v[0:3]
    s_add_u32 m0, s40, 48672
    ds_read_b128 v[88:91], v247 offset:49152
    v_readlane_b32 s85, v125, 63
    v_mfma_f32_16x16x32_bf16 v[112:115], a[224:227], v[36:39], v[112:115]
    s_add_u32 s69, s39, 0
    v_rcp_f32 v125, s85
    v_mfma_f32_16x16x32_bf16 v[112:115], a[236:239], v[28:31], v[112:115]
    v_mul_f32 v124, v124, v125
    v_cvt_pk_bf16_f32 v124, v124, v124
    v_mfma_f32_16x16x32_bf16 v[112:115], a[248:251], v[128:131], v[112:115]
    s_waitcnt lgkmcnt(2)
    buffer_load_dwordx4 v252, s[16:19], s70 offen nt lds
    v_mfma_f32_16x16x32_bf16 v[112:115], v[176:179], v[76:79], v[112:115]
    s_add_u32 m0, s40, 52416
    ds_read_b128 v[36:39], v247 offset:25600
    ds_read_b128 v[28:31], v247 offset:26624
    v_mfma_f32_16x16x32_bf16 v[112:115], v[188:191], v[64:67], v[112:115]
    s_add_u32 s70, s39, 86016
    ds_read_b128 v[108:111], v247 offset:27648
    v_subrev_u32 v106, 64512, v247
    v_mfma_f32_16x16x32_bf16 v[116:119], v[196:199], v[40:43], v[116:119]
    v_lshrrev_b32 v107, 8, v106
    v_lshl_add_u32 v105, v107, 4, s41
    v_mfma_f32_16x16x32_bf16 v[20:23], a[240:243], v[128:131], v[20:23]
    s_waitcnt lgkmcnt(3)
    v_lshrrev_b32 v107, 9, v106
    v_lshl_add_u32 v104, v107, 6, s41
    v_mfma_f32_16x16x32_bf16 v[20:23], a[252:255], v[76:79], v[20:23]
    buffer_load_dwordx4 v252, s[16:19], s71 offen nt lds
    v_mfma_f32_16x16x32_bf16 v[20:23], v[180:183], v[64:67], v[20:23]
    s_add_u32 m0, s40, 56160
    v_cvt_pk_bf16_f32 v116, v116, v117
    v_cvt_pk_bf16_f32 v117, v118, v119
    v_mfma_f32_16x16x32_bf16 v[20:23], v[192:195], v[88:91], v[20:23]
    s_add_u32 s71, s39, 172032
    ds_write_b64 v243, v[116:117] offset:32
    v_mfma_f32_16x16x32_bf16 v[0:3], v[184:187], v[64:67], v[0:3]
    s_waitcnt lgkmcnt(3)
    v_bfe_u32 v107, v106, 6, 2
    v_lshl_add_u32 v104, v107, 4, v104
    v_mfma_f32_16x16x32_bf16 v[0:3], v[196:199], v[88:91], v[0:3]
    s_waitcnt lgkmcnt(2)
    buffer_load_dwordx4 v252, s[16:19], s68 offen nt lds
    v_mfma_f32_16x16x32_bf16 v[112:115], v[200:203], v[88:91], v[112:115]
    s_waitcnt lgkmcnt(1)
    ds_read_b128 v[40:43], v247 offset:28672
    ds_read_b128 v[128:131], v247 offset:29696
    v_mfma_f32_16x16x32_bf16 v[76:79], a[0:3], v[36:39], 0
    s_add_u32 s68, s39, 258048
    ds_read_b128 v[116:119], v247 offset:30720
    v_cvt_pk_bf16_f32 v20, v20, v21
    v_mfma_f32_16x16x32_bf16 v[76:79], a[12:15], v[28:31], v[76:79]
    ds_write_b64 v243, v[4:5] offset:64
    v_mfma_f32_16x16x32_bf16 v[76:79], a[24:27], v[108:111], v[76:79]
    v_cvt_pk_bf16_f32 v21, v22, v23
    v_cvt_pk_bf16_f32 v0, v0, v1
    v_mfma_f32_16x16x32_bf16 v[64:67], a[4:7], v[36:39], 0
    ds_write_b64 v242, v[20:21] offset:0
    v_mfma_f32_16x16x32_bf16 v[64:67], a[16:19], v[28:31], v[64:67]
    v_cvt_pk_bf16_f32 v1, v2, v3
    v_cvt_pk_bf16_f32 v112, v112, v113
    v_mfma_f32_16x16x32_bf16 v[64:67], a[28:31], v[108:111], v[64:67]
    s_waitcnt lgkmcnt(4)
    ds_write_b64 v242, v[0:1] offset:32
    v_mfma_f32_16x16x32_bf16 v[64:67], a[40:43], v[40:43], v[64:67]
    s_waitcnt lgkmcnt(4)
    v_cvt_pk_bf16_f32 v113, v114, v115
    v_bfe_u32 v107, v106, 8, 1
    v_mfma_f32_16x16x32_bf16 v[64:67], a[52:55], v[128:131], v[64:67]
    s_waitcnt lgkmcnt(3)
    ds_write_b64 v242, v[112:113] offset:64
    v_mfma_f32_16x16x32_bf16 v[64:67], a[64:67], v[116:119], v[64:67]
    v_lshl_add_u32 v104, v107, 3, v104
    v_bfe_u32 v107, v106, 4, 2
    v_mfma_f32_16x16x32_bf16 v[88:91], a[8:11], v[36:39], 0
    v_lshl_add_u32 v104, v107, 1, v104
    v_cvt_pk_bf16_f32 v97, v98, v99
    v_mfma_f32_16x16x32_bf16 v[88:91], a[20:23], v[28:31], v[88:91]
    ds_write_b16 v104, v124 offset:0
    v_mfma_f32_16x16x32_bf16 v[88:91], a[32:35], v[108:111], v[88:91]
    v_cvt_pk_bf16_f32 v98, v132, v133
    v_cvt_pk_bf16_f32 v99, v134, v135
    v_mfma_f32_16x16x32_bf16 v[88:91], a[44:47], v[40:43], v[88:91]
    ds_read_b128 v[20:23], v105 offset:0
    v_cvt_pk_bf16_f32 v32, v32, v33
    v_mfma_f32_16x16x32_bf16 v[88:91], a[56:59], v[128:131], v[88:91]
    v_cvt_pk_bf16_f32 v33, v34, v35
    v_cvt_pk_bf16_f32 v34, v68, 0
    v_mfma_f32_16x16x32_bf16 v[88:91], a[68:71], v[116:119], v[88:91]
    ds_read_b128 v[112:115], v105 offset:64
    v_mov_b32 v35, 0
    v_mfma_f32_16x16x32_bf16 v[76:79], a[36:39], v[40:43], v[76:79]
    v_mfma_f32_16x16x32_bf16 v[76:79], a[48:51], v[128:131], v[76:79]
    v_mfma_f32_16x16x32_bf16 v[76:79], a[60:63], v[116:119], v[76:79]
    v_mfma_f32_16x16x32_bf16 v[36:39], v[228:231], v[96:99], 0
    v_mfma_f32_16x16x32_bf16 v[36:39], v[230:233], v[32:35], v[36:39]
    s_waitcnt lgkmcnt(1)
    v_cvt_pk_bf16_f32 v88, v88, v89
    v_cvt_pk_bf16_f32 v89, v90, v91
    v_mfma_f32_16x16x32_bf16 v[28:31], v[24:27], v[96:99], 0
    v_mfma_f32_16x16x32_bf16 v[28:31], v[216:219], v[32:35], v[28:31]
    s_waitcnt lgkmcnt(0)
    ds_read_b128 v[124:127], v247 offset:31744
    v_cvt_pk_bf16_f32 v76, v76, v77
    v_mfma_f32_16x16x32_bf16 v[108:111], v[16:19], v[96:99], 0
    ds_read_b128 v[68:71], v247 offset:32768
    v_rcp_f32 v36, v36
    v_mfma_f32_16x16x32_bf16 v[108:111], v[220:223], v[32:35], v[108:111]
    ds_read_b128 v[40:43], v247 offset:33792
    v_mul_f32 v28, v28, v36
    v_mfma_f32_16x16x32_bf16 v[116:119], v[100:103], v[96:99], 0
    v_mul_f32 v29, v29, v36
    v_mul_f32 v30, v30, v36
    v_mfma_f32_16x16x32_bf16 v[116:119], v[224:227], v[32:35], v[116:119]
    v_mul_f32 v31, v31, v36
    v_cvt_pk_bf16_f32 v28, v28, v29
    v_mfma_f32_16x16x32_bf16 v[96:99], v[24:27], v[20:23], 0
    v_mul_f32 v108, v108, v36
    v_mul_f32 v109, v109, v36
    v_mfma_f32_16x16x32_bf16 v[96:99], v[216:219], v[112:115], v[96:99]
    v_mul_f32 v110, v110, v36
    v_mul_f32 v111, v111, v36
    v_mfma_f32_16x16x32_bf16 v[32:35], v[16:19], v[20:23], 0
    s_waitcnt lgkmcnt(2)
    v_mul_f32 v116, v116, v36
    v_mul_f32 v117, v117, v36
    v_mfma_f32_16x16x32_bf16 v[32:35], v[220:223], v[112:115], v[32:35]
    s_waitcnt lgkmcnt(1)
    v_mul_f32 v118, v118, v36
    v_mul_f32 v119, v119, v36
    v_mfma_f32_16x16x32_bf16 v[24:27], v[100:103], v[20:23], 0
    s_waitcnt lgkmcnt(0)
    ds_read_b128 v[36:39], v247 offset:34816
    v_cvt_pk_bf16_f32 v29, v30, v31
    v_mfma_f32_16x16x32_bf16 v[24:27], v[224:227], v[112:115], v[24:27]
    ds_read_b128 v[100:103], v247 offset:35840
    v_cvt_pk_bf16_f32 v30, v108, v109
    v_mfma_f32_16x16x32_bf16 v[112:115], a[0:3], v[124:127], 0
    ds_read_b128 v[12:15], v247 offset:36864
    v_cvt_pk_bf16_f32 v31, v110, v111
    v_mfma_f32_16x16x32_bf16 v[112:115], a[12:15], v[68:71], v[112:115]
    ds_write_b128 v245, v[28:31] offset:56320
    v_mfma_f32_16x16x32_bf16 v[112:115], a[24:27], v[40:43], v[112:115]
    v_cvt_pk_bf16_f32 v116, v116, v117
    v_cvt_pk_bf16_f32 v117, v118, v119
    v_mfma_f32_16x16x32_bf16 v[8:11], a[4:7], v[124:127], 0
    v_cvt_pk_bf16_f32 v77, v78, v79
    v_cvt_pk_bf16_f32 v78, v64, v65
    v_mfma_f32_16x16x32_bf16 v[8:11], a[16:19], v[68:71], v[8:11]
    s_waitcnt lgkmcnt(3)
    ds_write_b64 v246, v[116:117] offset:56320
    v_mfma_f32_16x16x32_bf16 v[8:11], a[28:31], v[40:43], v[8:11]
    s_waitcnt lgkmcnt(3)
    v_cvt_pk_bf16_f32 v79, v66, v67
    v_cvt_pk_bf16_f32 v96, v96, v97
    v_mfma_f32_16x16x32_bf16 v[8:11], a[40:43], v[36:39], v[8:11]
    s_waitcnt lgkmcnt(2)
    v_cvt_pk_bf16_f32 v97, v98, v99
    v_cvt_pk_bf16_f32 v98, v32, v33
    v_mfma_f32_16x16x32_bf16 v[8:11], a[52:55], v[100:103], v[8:11]
    v_cvt_pk_bf16_f32 v99, v34, v35
    v_cvt_pk_bf16_f32 v24, v24, v25
    v_mfma_f32_16x16x32_bf16 v[8:11], a[64:67], v[12:15], v[8:11]
    v_cvt_pk_bf16_f32 v25, v26, v27
    v_mfma_f32_16x16x32_bf16 v[108:111], a[8:11], v[124:127], 0
    s_waitcnt vmcnt(7) lgkmcnt(0)
    s_barrier
    v_mfma_f32_16x16x32_bf16 v[108:111], a[20:23], v[68:71], v[108:111]
    v_mfma_f32_16x16x32_bf16 v[108:111], a[32:35], v[40:43], v[108:111]
    ds_read_b128 v[28:31], v236 offset:4160
    ds_read_b128 v[116:119], v236 offset:4192
    v_mfma_f32_16x16x32_bf16 v[108:111], a[44:47], v[36:39], v[108:111]
    ds_read_b128 v[32:35], v236 offset:4224
    ds_read_b128 v[56:59], v236 offset:0
    v_mfma_f32_16x16x32_bf16 v[108:111], a[56:59], v[100:103], v[108:111]
    ds_read_b128 v[60:63], v236 offset:3744
    ds_read_b128 v[0:3], v236 offset:32
    v_mfma_f32_16x16x32_bf16 v[108:111], a[68:71], v[12:15], v[108:111]
    ds_read_b128 v[4:7], v236 offset:3776
    ds_read_b128 v[128:131], v236 offset:64
    v_mfma_f32_16x16x32_bf16 v[112:115], a[36:39], v[36:39], v[112:115]
    ds_read_b128 v[132:135], v236 offset:3808
    ds_read_b128 v[16:19], v236 offset:7488
    v_mfma_f32_16x16x32_bf16 v[112:115], a[48:51], v[100:103], v[112:115]
    ds_read_b128 v[20:23], v239 offset:832
    ds_read_b128 v[64:67], v236 offset:7520
    v_mfma_f32_16x16x32_bf16 v[112:115], a[60:63], v[12:15], v[112:115]
    ds_read_b128 v[68:71], v239 offset:864
    s_waitcnt lgkmcnt(12)
    v_mfma_f32_16x16x32_bf16 v[124:127], v[136:139], v[28:31], 0
    ds_read_b128 v[36:39], v236 offset:7552
    s_waitcnt lgkmcnt(12)
    v_mfma_f32_16x16x32_bf16 v[100:103], v[148:151], v[116:119], 0
    ds_read_b128 v[40:43], v239 offset:896
    s_waitcnt lgkmcnt(12)
    v_mfma_f32_16x16x32_bf16 v[12:15], v[160:163], v[32:35], 0
    ds_read_b128 v[28:31], v247 offset:56320
    ds_read_b128 v[116:119], v247 offset:57344
    ds_read_b128 v[32:35], v253 offset:0
    s_waitcnt lgkmcnt(13)
    v_smfmac_f32_16x16x64_bf16 v[124:127], v[140:143], v[56:63], v255
    s_mov_b64 exec, s[60:61]
    ds_write_b128 v250, v[96:99] offset:1536
    ds_write_b64 v251, v[24:25] offset:1536
    s_mov_b64 exec, -1
    s_waitcnt lgkmcnt(10)
    v_smfmac_f32_16x16x64_bf16 v[100:103], v[152:155], v[0:7], v255
    ds_read_b128 v[96:99], v247 offset:58368
    v_smfmac_f32_16x16x64_bf16 v[12:15], v[164:167], v[128:135], v255
    s_waitcnt lgkmcnt(10)
    ds_read_b128 v[24:27], v253 offset:2800
    v_smfmac_f32_16x16x64_bf16 v[124:127], v[144:147], v[16:23], v255
    s_waitcnt lgkmcnt(10)
    ds_read_b128 v[56:59], v253 offset:5600
    s_waitcnt lgkmcnt(10)
    v_smfmac_f32_16x16x64_bf16 v[100:103], v[156:159], v[64:71], v255
    ds_read_b128 v[60:63], v247 offset:59392
    s_waitcnt lgkmcnt(9)
    v_smfmac_f32_16x16x64_bf16 v[12:15], v[168:171], v[36:43], v255
    ds_read_b128 v[36:39], v253 offset:8400
    s_waitcnt lgkmcnt(9)
    v_mfma_f32_16x16x32_bf16 v[92:95], a[216:219], v[28:31], v[92:95]
    s_waitcnt lgkmcnt(8)
    v_cvt_pk_bf16_f32 v40, v124, v125
    v_mfma_f32_16x16x32_bf16 v[92:95], a[228:231], v[116:119], v[92:95]
    ds_read_b128 v[0:3], v247 offset:60416
    s_waitcnt lgkmcnt(8)
    buffer_store_dwordx4 v[32:35], v254, s[32:35], s69 offen nt
    v_mfma_f32_16x16x32_bf16 v[84:87], a[220:223], v[28:31], v[84:87]
    s_add_u32 s69, s39, 344064
    v_cvt_pk_bf16_f32 v41, v126, v127
    v_cvt_pk_bf16_f32 v42, v100, v101
    v_mfma_f32_16x16x32_bf16 v[84:87], a[232:235], v[116:119], v[84:87]
    s_waitcnt lgkmcnt(5)
    v_cvt_pk_bf16_f32 v43, v102, v103
    v_mfma_f32_16x16x32_bf16 v[84:87], a[244:247], v[96:99], v[84:87]
    ds_read_b128 v[4:7], v247 offset:61440
    v_cvt_pk_bf16_f32 v32, v12, v13
    v_mfma_f32_16x16x32_bf16 v[120:123], a[224:227], v[28:31], v[120:123]
    v_cvt_pk_bf16_f32 v33, v14, v15
    v_cvt_pk_bf16_f32 v112, v112, v113
    v_mfma_f32_16x16x32_bf16 v[120:123], a[236:239], v[116:119], v[120:123]
    s_waitcnt lgkmcnt(5)
    v_cvt_pk_bf16_f32 v113, v114, v115
    v_cvt_pk_bf16_f32 v114, v8, v9
    v_mfma_f32_16x16x32_bf16 v[120:123], a[248:251], v[96:99], v[120:123]
    s_waitcnt lgkmcnt(4)
    ds_read_b128 v[28:31], v237 offset:4160
    s_waitcnt lgkmcnt(4)
    v_mfma_f32_16x16x32_bf16 v[120:123], v[176:179], v[60:63], v[120:123]
    ds_read_b128 v[116:119], v237 offset:4192
    buffer_store_dwordx4 v[24:27], v254, s[32:35], s70 offen nt
    s_waitcnt lgkmcnt(3)
    v_mfma_f32_16x16x32_bf16 v[120:123], v[188:191], v[0:3], v[120:123]
    s_add_u32 s70, s39, 430080
    ds_read_b128 v[24:27], v237 offset:4224
    s_waitcnt lgkmcnt(3)
    v_mfma_f32_16x16x32_bf16 v[120:123], v[200:203], v[4:7], v[120:123]
    ds_read_b128 v[128:131], v237 offset:0
    ds_read_b128 v[132:135], v237 offset:3744
    v_mfma_f32_16x16x32_bf16 v[92:95], a[240:243], v[96:99], v[92:95]
    ds_read_b128 v[16:19], v237 offset:32
    ds_read_b128 v[20:23], v237 offset:3776
    v_mfma_f32_16x16x32_bf16 v[92:95], a[252:255], v[60:63], v[92:95]
    ds_read_b128 v[64:67], v237 offset:64
    ds_read_b128 v[68:71], v237 offset:3808
    v_mfma_f32_16x16x32_bf16 v[92:95], v[180:183], v[0:3], v[92:95]
    s_waitcnt lgkmcnt(8)
    v_cvt_pk_bf16_f32 v120, v120, v121
    v_cvt_pk_bf16_f32 v121, v122, v123
    v_mfma_f32_16x16x32_bf16 v[92:95], v[192:195], v[4:7], v[92:95]
    s_waitcnt lgkmcnt(7)
    v_cvt_pk_bf16_f32 v115, v10, v11
    v_cvt_pk_bf16_f32 v90, v108, v109
    v_mfma_f32_16x16x32_bf16 v[84:87], v[172:175], v[60:63], v[84:87]
    buffer_store_dwordx4 v[56:59], v254, s[32:35], s71 offen nt
    v_mfma_f32_16x16x32_bf16 v[84:87], v[184:187], v[0:3], v[84:87]
    s_waitcnt lgkmcnt(5)
    ds_read_b128 v[56:59], v237 offset:7488
    ds_read_b128 v[60:63], v240 offset:832
    v_mfma_f32_16x16x32_bf16 v[84:87], v[196:199], v[4:7], v[84:87]
    s_waitcnt lgkmcnt(6)
    ds_read_b128 v[0:3], v237 offset:7520
    ds_read_b128 v[4:7], v240 offset:864
    v_mfma_f32_16x16x32_bf16 v[96:99], v[136:139], v[28:31], 0
    s_waitcnt lgkmcnt(7)
    v_cvt_pk_bf16_f32 v92, v92, v93
    v_cvt_pk_bf16_f32 v93, v94, v95
    v_mfma_f32_16x16x32_bf16 v[8:11], v[148:151], v[116:119], 0
    s_waitcnt lgkmcnt(6)
    ds_write_b64 v244, v[92:93] offset:0
    v_mfma_f32_16x16x32_bf16 v[28:31], v[160:163], v[24:27], 0
    s_waitcnt lgkmcnt(6)
    v_cvt_pk_bf16_f32 v84, v84, v85
    v_cvt_pk_bf16_f32 v85, v86, v87
    v_smfmac_f32_16x16x64_bf16 v[96:99], v[140:143], v[128:135], v255
    s_waitcnt lgkmcnt(5)
    ds_read_b128 v[128:131], v237 offset:7552
    v_smfmac_f32_16x16x64_bf16 v[8:11], v[152:155], v[16:23], v255
    ds_read_b128 v[132:135], v240 offset:896
    v_smfmac_f32_16x16x64_bf16 v[28:31], v[164:167], v[64:71], v255
    s_waitcnt lgkmcnt(6)
    s_waitcnt lgkmcnt(5)
    ds_read_b128 v[116:119], v238 offset:4160
    v_smfmac_f32_16x16x64_bf16 v[96:99], v[144:147], v[56:63], v255
    ds_read_b128 v[92:95], v238 offset:4192
    s_waitcnt lgkmcnt(5)
    v_smfmac_f32_16x16x64_bf16 v[8:11], v[156:159], v[0:7], v255
    ds_read_b128 v[24:27], v238 offset:4224
    v_mfma_f32_16x16x32_bf16 v[16:19], v[40:43], v[40:43], 0
    ds_read_b128 v[64:67], v238 offset:0
    ds_read_b128 v[68:71], v238 offset:3744
    v_mfma_f32_16x16x32_bf16 v[20:23], v[228:231], v[40:43], 0
    ds_read_b128 v[56:59], v238 offset:32
    ds_read_b128 v[60:63], v238 offset:3776
    ds_read_b128 v[0:3], v238 offset:64
    v_mfma_f32_16x16x16_bf16 v[16:19], v[32:33], v[32:33], v[16:19]
    s_waitcnt lgkmcnt(9)
    ds_read_b128 v[4:7], v238 offset:3808
    s_waitcnt lgkmcnt(9)
    v_smfmac_f32_16x16x64_bf16 v[28:31], v[168:171], v[128:135], v255
    ds_read_b128 v[128:131], v238 offset:7488
    v_mfma_f32_16x16x16_bf16 v[20:23], v[228:229], v[32:33], v[20:23]
    s_waitcnt lgkmcnt(9)
    ds_read_b128 v[132:135], v241 offset:832
    ds_write_b64 v244, v[84:85] offset:32
    v_mfma_f32_16x16x32_bf16 v[84:87], v[136:139], v[116:119], 0
    s_waitcnt lgkmcnt(9)
    buffer_store_dwordx4 v[36:39], v254, s[32:35], s68 offen nt
    v_mfma_f32_16x16x32_bf16 v[116:119], v[148:151], v[92:95], 0
    s_waitcnt lgkmcnt(7)
    ds_write_b64 v244, v[120:121] offset:64
    v_mfma_f32_16x16x32_bf16 v[36:39], v[160:163], v[24:27], 0
    s_waitcnt lgkmcnt(7)
    v_cndmask_b32 v16, v16, v17, s[52:53]
    v_cndmask_b32 v16, v16, v18, s[54:55]
    v_smfmac_f32_16x16x64_bf16 v[84:87], v[140:143], v[64:71], v255
    s_waitcnt lgkmcnt(6)
    ds_read_b128 v[64:67], v238 offset:7520
    v_smfmac_f32_16x16x64_bf16 v[116:119], v[152:155], v[56:63], v255
    s_waitcnt lgkmcnt(6)
    ds_read_b128 v[68:71], v241 offset:864
    s_waitcnt lgkmcnt(6)
    v_smfmac_f32_16x16x64_bf16 v[36:39], v[164:167], v[0:7], v255
    ds_read_b128 v[56:59], v238 offset:7552
    ds_read_b128 v[60:63], v241 offset:896
    s_waitcnt lgkmcnt(6)
    v_smfmac_f32_16x16x64_bf16 v[84:87], v[144:147], v[128:135], v255
    ds_read_b128 v[92:95], v247 offset:37888
    ds_read_b128 v[120:123], v247 offset:38912
    ds_read_b128 v[24:27], v247 offset:39936
    v_cndmask_b32 v21, v16, v19, s[56:57]
    ds_write_b64 v249, v[20:21] offset:0
    v_cvt_pk_bf16_f32 v91, v110, v111
    v_cvt_pk_bf16_f32 v108, v96, v97
    v_cvt_pk_bf16_f32 v109, v98, v99
    s_waitcnt lgkmcnt(6)
    v_smfmac_f32_16x16x64_bf16 v[116:119], v[156:159], v[64:71], v255
    s_add_u32 s71, s39, 516096
    ds_read_b128 v[0:3], v247 offset:25600
    v_cvt_pk_bf16_f32 v4, v84, v85
    v_cvt_pk_bf16_f32 v5, v86, v87
    v_cvt_pk_bf16_f32 v110, v8, v9
    v_cvt_pk_bf16_f32 v111, v10, v11
    s_waitcnt lgkmcnt(5)
    v_smfmac_f32_16x16x64_bf16 v[36:39], v[168:171], v[56:63], v255
    v_cvt_pk_bf16_f32 v6, v116, v117
    v_mfma_f32_16x16x32_bf16 v[128:131], v[108:111], v[108:111], 0
    s_waitcnt lgkmcnt(4)
    v_cvt_pk_bf16_f32 v7, v118, v119
    v_cvt_pk_bf16_f32 v34, v28, v29
    v_mfma_f32_16x16x32_bf16 v[132:135], v[228:231], v[108:111], 0
    v_cvt_pk_bf16_f32 v35, v30, v31
    v_mfma_f32_16x16x32_bf16 v[16:19], v[4:7], v[4:7], 0
    s_waitcnt lgkmcnt(3)
    v_cvt_pk_bf16_f32 v20, v36, v37
    v_cvt_pk_bf16_f32 v21, v38, v39
    v_mfma_f32_16x16x32_bf16 v[68:71], v[228:231], v[4:7], 0
    s_waitcnt lgkmcnt(2)
    v_mfma_f32_16x16x16_bf16 v[128:131], v[34:35], v[34:35], v[128:131]
    v_mfma_f32_16x16x16_bf16 v[16:19], v[20:21], v[20:21], v[16:19]
    s_waitcnt lgkmcnt(0)
    v_mfma_f32_16x16x16_bf16 v[132:135], v[228:229], v[34:35], v[132:135]
    v_mfma_f32_16x16x32_bf16 v[64:67], a[0:3], v[92:95], 0
    ds_read_b128 v[56:59], v247 offset:40960
    v_mfma_f32_16x16x32_bf16 v[64:67], a[12:15], v[120:123], v[64:67]
    ds_read_b128 v[60:63], v247 offset:26624
    v_mfma_f32_16x16x32_bf16 v[64:67], a[24:27], v[24:27], v[64:67]
    v_cndmask_b32 v128, v128, v129, s[52:53]
    v_cndmask_b32 v16, v16, v17, s[52:53]
    v_mfma_f32_16x16x16_bf16 v[68:71], v[228:229], v[20:21], v[68:71]
    v_cndmask_b32 v16, v16, v18, s[54:55]
    v_cndmask_b32 v128, v128, v130, s[54:55]
    v_cndmask_b32 v133, v128, v131, s[56:57]
    v_mfma_f32_16x16x32_bf16 v[128:131], a[4:7], v[92:95], 0
    ds_write_b64 v249, v[132:133] offset:256
    v_mfma_f32_16x16x32_bf16 v[128:131], a[16:19], v[120:123], v[128:131]
    v_mfma_f32_16x16x32_bf16 v[128:131], a[28:31], v[24:27], v[128:131]
    s_waitcnt lgkmcnt(2)
    ds_read_b128 v[132:135], v247 offset:41984
    v_cndmask_b32 v69, v16, v19, s[56:57]
    v_mfma_f32_16x16x32_bf16 v[128:131], a[40:43], v[56:59], v[128:131]
    s_waitcnt lgkmcnt(2)
    ds_read_b128 v[16:19], v247 offset:43008
    ds_write_b64 v249, v[68:69] offset:512
    v_mfma_f32_16x16x32_bf16 v[68:71], a[8:11], v[92:95], 0
    v_mfma_f32_16x16x32_bf16 v[68:71], a[20:23], v[120:123], v[68:71]
    v_mfma_f32_16x16x32_bf16 v[68:71], a[32:35], v[24:27], v[68:71]
    v_mfma_f32_16x16x32_bf16 v[68:71], a[44:47], v[56:59], v[68:71]
    s_waitcnt lgkmcnt(2)
    v_mfma_f32_16x16x32_bf16 v[68:71], a[56:59], v[132:135], v[68:71]
    s_waitcnt lgkmcnt(1)
    v_mfma_f32_16x16x32_bf16 v[68:71], a[68:71], v[16:19], v[68:71]
    s_waitcnt lgkmcnt(0)
    s_barrier
    v_mfma_f32_16x16x32_bf16 v[92:95], a[144:147], v[0:3], 0
    v_mfma_f32_16x16x32_bf16 v[92:95], a[156:159], v[60:63], v[92:95]
    ds_read_b128 v[120:123], v247 offset:23552
    ds_read_b128 v[24:27], v247 offset:24576
    v_mfma_f32_16x16x32_bf16 v[64:67], a[36:39], v[56:59], v[64:67]
    ds_read_b128 v[56:59], v253 offset:11200
    v_cvt_pk_bf16_f32 v68, v68, v69
    v_mfma_f32_16x16x32_bf16 v[64:67], a[48:51], v[132:135], v[64:67]
    v_cvt_pk_bf16_f32 v69, v70, v71
    v_mfma_f32_16x16x32_bf16 v[64:67], a[60:63], v[16:19], v[64:67]
    v_mfma_f32_16x16x32_bf16 v[128:131], a[52:55], v[132:135], v[128:131]
    ds_read_b128 v[132:135], v253 offset:14000
    v_mfma_f32_16x16x32_bf16 v[128:131], a[64:67], v[16:19], v[128:131]
    v_mfma_f32_16x16x32_bf16 v[16:19], a[148:151], v[0:3], 0
    s_waitcnt lgkmcnt(3)
    v_add_f32 v120, v120, v122
    v_mfma_f32_16x16x32_bf16 v[16:19], a[160:163], v[60:63], v[16:19]
    v_add_f32 v121, v121, v123
    s_waitcnt lgkmcnt(2)
    v_add_f32 v24, v24, v26
    v_add_f32 v25, v25, v27
    v_add_f32 v120, v120, v24
    v_add_f32 v121, v121, v25
    v_mul_f32 v122, s45, v120
    v_mul_f32 v121, s45, v121
    v_fma_f32 v121, -v122, v122, v121
    v_max_f32 v121, 0, v121
    v_add_f32 v121, s46, v121
    v_rsq_f32 v120, v121
    s_waitcnt lgkmcnt(1)
    buffer_store_dwordx4 v[56:59], v254, s[32:35], s69 offen nt
    v_mul_f32 v121, -v122, v120
    v_cvt_pk_bf16_f32 v64, v64, v65
    v_mfma_f32_16x16x32_bf16 v[56:59], a[152:155], v[0:3], 0
    s_waitcnt lgkmcnt(0)
    ds_write_b64 v245, v[120:121] offset:19456
    v_mfma_f32_16x16x32_bf16 v[56:59], a[164:167], v[60:63], v[56:59]
    v_cvt_pk_bf16_f32 v65, v66, v67
    v_cvt_pk_bf16_f32 v66, v128, v129
    v_cvt_pk_bf16_f32 v67, v130, v131
    v_mfma_f32_16x16x32_bf16 v[128:131], v[0:3], a[72:75], 0
    s_mov_b32 vcc_lo, 0
    ds_read_b64 v[24:25], v248 offset:0
    ds_read_b64 v[26:27], v248 offset:256
    v_mfma_f32_16x16x32_bf16 v[128:131], v[60:63], a[84:87], v[128:131]
    s_mov_b32 vcc_hi, 0x20000
    ds_read_b64 v[122:123], v248 offset:512
    buffer_store_dwordx4 v[132:135], v254, s[32:35], s70 offen nt
    s_nop 1
    ds_read_b128 v[132:135], v247 offset:27648
    s_waitcnt lgkmcnt(3)
    v_fma_f32 v124, v124, v24, v25
    v_fma_f32 v125, v125, v24, v25
    v_fma_f32 v126, v126, v24, v25
    v_fma_f32 v127, v127, v24, v25
    v_fma_f32 v100, v100, v24, v25
    v_fma_f32 v101, v101, v24, v25
    v_fma_f32 v102, v102, v24, v25
    v_fma_f32 v103, v103, v24, v25
    v_fma_f32 v12, v12, v24, v25
    v_fma_f32 v13, v13, v24, v25
    v_fma_f32 v14, v14, v24, v25
    v_fma_f32 v15, v15, v24, v25
    v_cvt_pk_bf16_f32 v124, v124, v125
    v_cvt_pk_bf16_f32 v125, v126, v127
    v_cvt_pk_bf16_f32 v126, v100, v101
    v_cvt_pk_bf16_f32 v127, v102, v103
    v_mfma_f32_16x16x32_bf16 v[100:103], v[0:3], a[76:79], 0
    s_waitcnt lgkmcnt(1)
    ds_write_b128 v245, v[124:127] offset:1024
    v_mfma_f32_16x16x32_bf16 v[100:103], v[60:63], a[88:91], v[100:103]
    s_waitcnt lgkmcnt(1)
    v_cvt_pk_bf16_f32 v12, v12, v13
    v_cvt_pk_bf16_f32 v13, v14, v15
    v_mfma_f32_16x16x32_bf16 v[100:103], v[132:135], a[100:103], v[100:103]
    v_fma_f32 v96, v96, v26, v27
    v_fma_f32 v97, v97, v26, v27
    v_mfma_f32_16x16x32_bf16 v[124:127], v[0:3], a[80:83], 0
    ds_read_b128 v[0:3], v247 offset:28672
    v_fma_f32 v98, v98, v26, v27
    v_mfma_f32_16x16x32_bf16 v[124:127], v[60:63], a[92:95], v[124:127]
    ds_write_b64 v246, v[12:13] offset:1024
    v_mfma_f32_16x16x32_bf16 v[124:127], v[132:135], a[104:107], v[124:127]
    v_fma_f32 v99, v99, v26, v27
    v_fma_f32 v8, v8, v26, v27
    v_mfma_f32_16x16x32_bf16 v[92:95], a[168:171], v[132:135], v[92:95]
    ds_read_b128 v[60:63], v247 offset:29696
    ds_read_b128 v[12:15], v247 offset:30720
    v_mfma_f32_16x16x32_bf16 v[16:19], a[172:175], v[132:135], v[16:19]
    v_fma_f32 v9, v9, v26, v27
    v_fma_f32 v10, v10, v26, v27
    v_mfma_f32_16x16x32_bf16 v[56:59], a[176:179], v[132:135], v[56:59]
    s_waitcnt lgkmcnt(3)
    v_fma_f32 v11, v11, v26, v27
    v_mfma_f32_16x16x32_bf16 v[56:59], a[188:191], v[0:3], v[56:59]
    v_fma_f32 v28, v28, v26, v27
    v_fma_f32 v29, v29, v26, v27
    v_mfma_f32_16x16x32_bf16 v[92:95], a[180:183], v[0:3], v[92:95]
    v_fma_f32 v30, v30, v26, v27
    v_fma_f32 v31, v31, v26, v27
    v_mfma_f32_16x16x32_bf16 v[16:19], a[184:187], v[0:3], v[16:19]
    ds_read_b128 v[24:27], v253 offset:16800
    v_cvt_pk_bf16_f32 v96, v96, v97
    v_mfma_f32_16x16x32_bf16 v[128:131], v[132:135], a[96:99], v[128:131]
    v_cvt_pk_bf16_f32 v97, v98, v99
    v_cvt_pk_bf16_f32 v98, v8, v9
    v_mfma_f32_16x16x32_bf16 v[128:131], v[0:3], a[108:111], v[128:131]
    s_waitcnt lgkmcnt(2)
    v_cvt_pk_bf16_f32 v99, v10, v11
    v_cvt_pk_bf16_f32 v28, v28, v29
    v_mfma_f32_16x16x32_bf16 v[128:131], v[60:63], a[120:123], v[128:131]
    s_waitcnt lgkmcnt(1)
    ds_write_b128 v245, v[96:99] offset:7168
    v_mfma_f32_16x16x32_bf16 v[128:131], v[12:15], a[132:135], v[128:131]
    v_cvt_pk_bf16_f32 v29, v30, v31
    v_fma_f32 v84, v84, v122, v123
    v_mfma_f32_16x16x32_bf16 v[100:103], v[0:3], a[112:115], v[100:103]
    s_mov_b64 exec, s[48:49]
    s_waitcnt lgkmcnt(1)
    buffer_store_dwordx4 v[24:27], v254, s[32:35], s71 offen nt
    s_mov_b64 exec, -1
    v_mfma_f32_16x16x32_bf16 v[100:103], v[60:63], a[124:127], v[100:103]
    ds_read_b128 v[132:135], v247 offset:31744
    v_cvt_pk_bf16_f32 v128, v128, v129
    v_mfma_f32_16x16x32_bf16 v[100:103], v[12:15], a[136:139], v[100:103]
    ds_read_b128 v[8:11], v247 offset:32768
    v_cvt_pk_bf16_f32 v129, v130, v131
    v_mfma_f32_16x16x32_bf16 v[124:127], v[0:3], a[116:119], v[124:127]
    ds_write_b64 v246, v[28:29] offset:7168
    v_mfma_f32_16x16x32_bf16 v[124:127], v[60:63], a[128:131], v[124:127]
    v_fma_f32 v85, v85, v122, v123
    v_fma_f32 v86, v86, v122, v123
    v_mfma_f32_16x16x32_bf16 v[124:127], v[12:15], a[140:143], v[124:127]
    v_cvt_pk_bf16_f32 v100, v100, v101
    v_cvt_pk_bf16_f32 v101, v102, v103
    v_mfma_f32_16x16x32_bf16 v[92:95], a[192:195], v[60:63], v[92:95]
    v_fma_f32 v87, v87, v122, v123
    v_fma_f32 v116, v116, v122, v123
    v_mfma_f32_16x16x32_bf16 v[92:95], a[204:207], v[12:15], v[92:95]
    v_fma_f32 v117, v117, v122, v123
    v_fma_f32 v118, v118, v122, v123
    v_mfma_f32_16x16x32_bf16 v[16:19], a[196:199], v[60:63], v[16:19]
    s_waitcnt lgkmcnt(2)
    v_cvt_pk_bf16_f32 v124, v124, v125
    v_cvt_pk_bf16_f32 v125, v126, v127
    v_mfma_f32_16x16x32_bf16 v[16:19], a[208:211], v[12:15], v[16:19]
    s_waitcnt lgkmcnt(1)
    v_fma_f32 v119, v119, v122, v123
    v_cvt_pk_bf16_f32 v92, v92, v93
    v_mfma_f32_16x16x32_bf16 v[56:59], a[200:203], v[60:63], v[56:59]
    v_cvt_pk_bf16_f32 v93, v94, v95
    v_fma_f32 v36, v36, v122, v123
    v_mfma_f32_16x16x32_bf16 v[56:59], a[212:215], v[12:15], v[56:59]
    v_fma_f32 v37, v37, v122, v123
    v_cvt_pk_bf16_f32 v94, v16, v17
    v_mfma_f32_16x16x32_bf16 v[96:99], a[144:147], v[132:135], 0
    v_cvt_pk_bf16_f32 v95, v18, v19
    v_fma_f32 v38, v38, v122, v123
    v_mfma_f32_16x16x32_bf16 v[96:99], a[156:159], v[8:11], v[96:99]
    v_fma_f32 v39, v39, v122, v123
    v_cvt_pk_bf16_f32 v84, v84, v85
    v_mfma_f32_16x16x32_bf16 v[0:3], v[76:79], v[92:95], 0
    v_cvt_pk_bf16_f32 v70, v56, v57
    v_cvt_pk_bf16_f32 v71, v58, v59
    v_mfma_f32_16x16x32_bf16 v[12:15], v[112:115], v[92:95], 0
    v_cvt_pk_bf16_f32 v85, v86, v87
    v_cvt_pk_bf16_f32 v86, v116, v117
    v_mfma_f32_16x16x32_bf16 v[16:19], v[64:67], v[92:95], 0
    v_cvt_pk_bf16_f32 v87, v118, v119
    v_cvt_pk_bf16_f32 v36, v36, v37
    v_mfma_f32_16x16x32_bf16 v[120:123], v[204:207], v[92:95], 0
    ds_write_b128 v245, v[84:87] offset:13312
    v_mfma_f32_16x16x16_bf16 v[0:3], v[88:89], v[70:71], v[0:3]
    v_cvt_pk_bf16_f32 v37, v38, v39
    v_mfma_f32_16x16x16_bf16 v[12:15], v[90:91], v[70:71], v[12:15]
    v_mfma_f32_16x16x16_bf16 v[16:19], v[68:69], v[70:71], v[16:19]
    ds_write_b64 v246, v[36:37] offset:13312
    v_mfma_f32_16x16x16_bf16 v[120:123], v[208:209], v[70:71], v[120:123]
    v_mfma_f32_16x16x32_bf16 v[116:119], a[148:151], v[132:135], 0
    ds_read_b128 v[92:95], v247 offset:33792
    ds_read_b128 v[84:87], v247 offset:34816
    v_mfma_f32_16x16x32_bf16 v[116:119], a[160:163], v[8:11], v[116:119]
    v_mfma_f32_16x16x32_bf16 v[36:39], a[152:155], v[132:135], 0
    v_mfma_f32_16x16x32_bf16 v[36:39], a[164:167], v[8:11], v[36:39]
    v_mfma_f32_16x16x32_bf16 v[24:27], v[132:135], a[72:75], 0
    v_mfma_f32_16x16x32_bf16 v[24:27], v[8:11], a[84:87], v[24:27]
    v_max3_f32 v120, v0, v1, v121
    v_max3_f32 v122, v2, v3, v12
    v_mfma_f32_16x16x32_bf16 v[28:31], v[132:135], a[76:79], 0
    v_max3_f32 v120, v120, v13, v14
    v_max3_f32 v122, v122, v15, v16
    v_mfma_f32_16x16x32_bf16 v[28:31], v[8:11], a[88:91], v[28:31]
    s_waitcnt lgkmcnt(1)
    v_max3_f32 v120, v120, v17, v18
    v_max3_f32 v120, v120, v122, v19
    v_mfma_f32_16x16x32_bf16 v[28:31], v[92:95], a[100:103], v[28:31]
    s_waitcnt lgkmcnt(0)
    v_mov_b32 v122, v120
    v_mfma_f32_16x16x32_bf16 v[28:31], v[84:87], a[112:115], v[28:31]
    v_mfma_f32_16x16x32_bf16 v[60:63], v[132:135], a[80:83], 0
    v_permlane32_swap_b32 v120, v122
    v_mfma_f32_16x16x32_bf16 v[60:63], v[8:11], a[92:95], v[60:63]
    ds_read_b128 v[56:59], v247 offset:35840
    v_max_f32 v120, v120, v122
    v_mfma_f32_16x16x32_bf16 v[60:63], v[92:95], a[104:107], v[60:63]
    ds_read_b128 v[132:135], v247 offset:36864
    v_mov_b32 v122, v120
    v_mfma_f32_16x16x32_bf16 v[60:63], v[84:87], a[116:119], v[60:63]
    v_mfma_f32_16x16x32_bf16 v[96:99], a[168:171], v[92:95], v[96:99]
    v_permlane16_swap_b32 v120, v122
    v_mfma_f32_16x16x32_bf16 v[96:99], a[180:183], v[84:87], v[96:99]
    v_max_f32 v120, v120, v122
    v_mul_f32 v120, s44, v120
    v_mfma_f32_16x16x32_bf16 v[116:119], a[172:175], v[92:95], v[116:119]
    v_fma_f32 v0, v0, s44, -v120
    v_fma_f32 v1, v1, s44, -v120
    v_mfma_f32_16x16x32_bf16 v[116:119], a[184:187], v[84:87], v[116:119]
    s_waitcnt lgkmcnt(1)
    v_fma_f32 v2, v2, s44, -v120
    v_mfma_f32_16x16x32_bf16 v[116:119], a[196:199], v[56:59], v[116:119]
    s_waitcnt lgkmcnt(0)
    v_fma_f32 v3, v3, s44, -v120
    v_mfma_f32_16x16x32_bf16 v[116:119], a[208:211], v[132:135], v[116:119]
    v_fma_f32 v12, v12, s44, -v120
    v_fma_f32 v13, v13, s44, -v120
    v_mfma_f32_16x16x32_bf16 v[36:39], a[176:179], v[92:95], v[36:39]
    v_fma_f32 v14, v14, s44, -v120
    v_fma_f32 v15, v15, s44, -v120
    v_mfma_f32_16x16x32_bf16 v[36:39], a[188:191], v[84:87], v[36:39]
    v_fma_f32 v16, v16, s44, -v120
    v_fma_f32 v17, v17, s44, -v120
    v_mfma_f32_16x16x32_bf16 v[36:39], a[200:203], v[56:59], v[36:39]
    v_fma_f32 v18, v18, s44, -v120
    v_fma_f32 v19, v19, s44, -v120
    v_mfma_f32_16x16x32_bf16 v[36:39], a[212:215], v[132:135], v[36:39]
    ds_read_b128 v[8:11], v247 offset:37888
    v_fma_f32 v121, v121, s44, -v120
    v_mfma_f32_16x16x32_bf16 v[24:27], v[92:95], a[96:99], v[24:27]
    ds_read_b128 v[92:95], v247 offset:38912
    v_exp_f32 v0, v0
    v_mfma_f32_16x16x32_bf16 v[24:27], v[84:87], a[108:111], v[24:27]
    v_exp_f32 v1, v1
    v_mfma_f32_16x16x32_bf16 v[24:27], v[56:59], a[120:123], v[24:27]
    v_cvt_pk_bf16_f32 v70, v36, v37
    v_cvt_pk_bf16_f32 v71, v38, v39
    v_mfma_f32_16x16x32_bf16 v[24:27], v[132:135], a[132:135], v[24:27]
    v_exp_f32 v2, v2
    v_mfma_f32_16x16x32_bf16 v[96:99], a[192:195], v[56:59], v[96:99]
    v_exp_f32 v3, v3
    v_mfma_f32_16x16x32_bf16 v[96:99], a[204:207], v[132:135], v[96:99]
    v_exp_f32 v12, v12
    v_mfma_f32_16x16x32_bf16 v[28:31], v[56:59], a[124:127], v[28:31]
    s_waitcnt lgkmcnt(1)
    v_exp_f32 v13, v13
    v_mfma_f32_16x16x32_bf16 v[28:31], v[132:135], a[136:139], v[28:31]
    s_waitcnt lgkmcnt(0)
    v_cvt_pk_bf16_f32 v130, v24, v25
    v_cvt_pk_bf16_f32 v131, v26, v27
    v_mfma_f32_16x16x32_bf16 v[60:63], v[56:59], a[128:131], v[60:63]
    v_cvt_pk_bf16_f32 v96, v96, v97
    v_cvt_pk_bf16_f32 v97, v98, v99
    v_mfma_f32_16x16x32_bf16 v[60:63], v[132:135], a[140:143], v[60:63]
    v_cvt_pk_bf16_f32 v98, v116, v117
    v_cvt_pk_bf16_f32 v99, v118, v119
    v_mfma_f32_16x16x32_bf16 v[84:87], a[144:147], v[8:11], 0
    v_cvt_pk_bf16_f32 v102, v28, v29
    v_cvt_pk_bf16_f32 v103, v30, v31
    v_mfma_f32_16x16x32_bf16 v[84:87], a[156:159], v[92:95], v[84:87]
    v_exp_f32 v14, v14
    v_mfma_f32_16x16x32_bf16 v[36:39], v[76:79], v[96:99], 0
    v_cvt_pk_bf16_f32 v126, v60, v61
    v_cvt_pk_bf16_f32 v127, v62, v63
    v_mfma_f32_16x16x32_bf16 v[132:135], v[112:115], v[96:99], 0
    s_add_u32 s68, s39, 602112
    v_exp_f32 v15, v15
    v_mfma_f32_16x16x32_bf16 v[116:119], v[64:67], v[96:99], 0
    s_add_u32 s69, s39, 688128
    v_exp_f32 v16, v16
    v_mfma_f32_16x16x32_bf16 v[24:27], v[204:207], v[96:99], 0
    v_exp_f32 v17, v17
    v_mfma_f32_16x16x16_bf16 v[36:39], v[88:89], v[70:71], v[36:39]
    v_exp_f32 v18, v18
    v_mfma_f32_16x16x16_bf16 v[132:135], v[90:91], v[70:71], v[132:135]
    v_exp_f32 v19, v19
    v_mfma_f32_16x16x16_bf16 v[116:119], v[68:69], v[70:71], v[116:119]
    v_exp_f32 v121, v121
    v_mfma_f32_16x16x16_bf16 v[24:27], v[208:209], v[70:71], v[24:27]
    ds_read_b128 v[28:31], v247 offset:39936
    v_cvt_pk_bf16_f32 v0, v0, v1
    v_mfma_f32_16x16x32_bf16 v[96:99], a[148:151], v[8:11], 0
    v_cvt_pk_bf16_f32 v1, v2, v3
    v_cvt_pk_bf16_f32 v2, v12, v13
    v_mfma_f32_16x16x32_bf16 v[96:99], a[160:163], v[92:95], v[96:99]
    v_cvt_pk_bf16_f32 v3, v14, v15
    v_cvt_pk_bf16_f32 v16, v16, v17
    v_mfma_f32_16x16x32_bf16 v[12:15], a[152:155], v[8:11], 0
    v_max3_f32 v24, v36, v37, v25
    v_max3_f32 v26, v38, v39, v132
    v_mfma_f32_16x16x32_bf16 v[12:15], a[164:167], v[92:95], v[12:15]
    v_max3_f32 v24, v24, v133, v134
    v_max3_f32 v26, v26, v135, v116
    v_mfma_f32_16x16x32_bf16 v[56:59], v[8:11], a[72:75], 0
    v_max3_f32 v24, v24, v117, v118
    v_max3_f32 v24, v24, v26, v119
    v_mfma_f32_16x16x32_bf16 v[56:59], v[92:95], a[84:87], v[56:59]
    s_waitcnt lgkmcnt(0)
    v_mov_b32 v26, v24
    v_mfma_f32_16x16x32_bf16 v[56:59], v[28:31], a[96:99], v[56:59]
    v_cvt_pk_bf16_f32 v17, v18, v19
    v_permlane32_swap_b32 v24, v26
    v_mfma_f32_16x16x32_bf16 v[60:63], v[8:11], a[76:79], 0
    v_max_f32 v24, v24, v26
    v_mov_b32 v26, v24
    v_mfma_f32_16x16x32_bf16 v[60:63], v[92:95], a[88:91], v[60:63]
    v_cvt_pk_bf16_f32 v18, 0, v121
    v_permlane16_swap_b32 v24, v26
    v_mfma_f32_16x16x32_bf16 v[60:63], v[28:31], a[100:103], v[60:63]
    v_max_f32 v24, v24, v26
    v_mul_f32 v24, s44, v24
    v_mfma_f32_16x16x32_bf16 v[120:123], v[8:11], a[80:83], 0
    ds_read_b128 v[8:11], v247 offset:40960
    v_fma_f32 v36, v36, s44, -v24
    v_mfma_f32_16x16x32_bf16 v[120:123], v[92:95], a[92:95], v[120:123]
    v_fma_f32 v37, v37, s44, -v24
    v_fma_f32 v38, v38, s44, -v24
    v_mfma_f32_16x16x32_bf16 v[120:123], v[28:31], a[104:107], v[120:123]
    v_fma_f32 v39, v39, s44, -v24
    v_fma_f32 v132, v132, s44, -v24
    v_mfma_f32_16x16x32_bf16 v[92:95], v[228:231], v[0:3], 0
    v_fma_f32 v133, v133, s44, -v24
    v_fma_f32 v134, v134, s44, -v24
    v_mfma_f32_16x16x32_bf16 v[84:87], a[168:171], v[28:31], v[84:87]
    v_fma_f32 v135, v135, s44, -v24
    v_fma_f32 v116, v116, s44, -v24
    v_mfma_f32_16x16x32_bf16 v[96:99], a[172:175], v[28:31], v[96:99]
    v_fma_f32 v117, v117, s44, -v24
    v_fma_f32 v118, v118, s44, -v24
    v_mfma_f32_16x16x32_bf16 v[12:15], a[176:179], v[28:31], v[12:15]
    ds_read_b128 v[28:31], v247 offset:41984
    s_waitcnt lgkmcnt(1)
    v_mfma_f32_16x16x32_bf16 v[12:15], a[188:191], v[8:11], v[12:15]
    v_fma_f32 v119, v119, s44, -v24
    v_fma_f32 v25, v25, s44, -v24
    v_mfma_f32_16x16x32_bf16 v[84:87], a[180:183], v[8:11], v[84:87]
    v_exp_f32 v36, v36
    v_mfma_f32_16x16x32_bf16 v[96:99], a[184:187], v[8:11], v[96:99]
    v_exp_f32 v37, v37
    v_mfma_f32_16x16x32_bf16 v[56:59], v[8:11], a[108:111], v[56:59]
    v_exp_f32 v38, v38
    v_mfma_f32_16x16x32_bf16 v[60:63], v[8:11], a[112:115], v[60:63]
    v_exp_f32 v39, v39
    v_mfma_f32_16x16x32_bf16 v[120:123], v[8:11], a[116:119], v[120:123]
    ds_read_b128 v[8:11], v247 offset:43008
    s_waitcnt lgkmcnt(1)
    v_mfma_f32_16x16x32_bf16 v[120:123], v[28:31], a[128:131], v[120:123]
    v_exp_f32 v132, v132
    v_mfma_f32_16x16x32_bf16 v[84:87], a[192:195], v[28:31], v[84:87]
    v_exp_f32 v133, v133
    v_mfma_f32_16x16x32_bf16 v[96:99], a[196:199], v[28:31], v[96:99]
    v_exp_f32 v134, v134
    v_mfma_f32_16x16x32_bf16 v[12:15], a[200:203], v[28:31], v[12:15]
    v_exp_f32 v135, v135
    v_mfma_f32_16x16x32_bf16 v[56:59], v[28:31], a[120:123], v[56:59]
    v_exp_f32 v116, v116
    v_mfma_f32_16x16x32_bf16 v[60:63], v[28:31], a[124:127], v[60:63]
    s_waitcnt lgkmcnt(0)
    v_exp_f32 v117, v117
    v_mfma_f32_16x16x32_bf16 v[60:63], v[8:11], a[136:139], v[60:63]
    v_exp_f32 v118, v118
    v_mfma_f32_16x16x32_bf16 v[28:31], v[128:131], v[0:3], 0
    v_exp_f32 v119, v119
    v_mfma_f32_16x16x32_bf16 v[84:87], a[204:207], v[8:11], v[84:87]
    v_exp_f32 v25, v25
    v_mfma_f32_16x16x32_bf16 v[96:99], a[208:211], v[8:11], v[96:99]
    v_cvt_pk_bf16_f32 v36, v36, v37
    v_cvt_pk_bf16_f32 v37, v38, v39
    v_mfma_f32_16x16x32_bf16 v[12:15], a[212:215], v[8:11], v[12:15]
    v_cvt_pk_bf16_f32 v38, v132, v133
    v_cvt_pk_bf16_f32 v39, v134, v135
    v_mfma_f32_16x16x32_bf16 v[132:135], v[100:103], v[0:3], 0
    v_cvt_pk_bf16_f32 v116, v116, v117
    v_cvt_pk_bf16_f32 v117, v118, v119
    v_mfma_f32_16x16x32_bf16 v[56:59], v[8:11], a[132:135], v[56:59]
    v_cvt_pk_bf16_f32 v118, 0, v25
    v_mov_b32 v119, 0
    v_mfma_f32_16x16x32_bf16 v[24:27], v[124:127], v[0:3], 0
    v_cvt_pk_bf16_f32 v84, v84, v85
    v_cvt_pk_bf16_f32 v85, v86, v87
    v_mfma_f32_16x16x32_bf16 v[120:123], v[8:11], a[140:143], v[120:123]
    v_mov_b32 v19, 0
    v_cvt_pk_bf16_f32 v86, v96, v97
    v_mfma_f32_16x16x32_bf16 v[0:3], v[228:231], v[36:39], 0
    v_cvt_pk_bf16_f32 v87, v98, v99
    v_cvt_pk_bf16_f32 v70, v12, v13
    v_mfma_f32_16x16x32_bf16 v[0:3], v[230:233], v[116:119], v[0:3]
    v_cvt_pk_bf16_f32 v71, v14, v15
    v_cvt_pk_bf16_f32 v216, v56, v57
    v_mfma_f32_16x16x32_bf16 v[92:95], v[230:233], v[16:19], v[92:95]
    v_cvt_pk_bf16_f32 v217, v58, v59
    v_cvt_pk_bf16_f32 v220, v60, v61
    v_mfma_f32_16x16x32_bf16 v[96:99], v[76:79], v[84:87], 0
    v_cvt_pk_bf16_f32 v221, v62, v63
    v_cvt_pk_bf16_f32 v224, v120, v121
    v_mfma_f32_16x16x32_bf16 v[28:31], v[216:219], v[16:19], v[28:31]
    v_rcp_f32 v0, v0
    v_mfma_f32_16x16x32_bf16 v[132:135], v[220:223], v[16:19], v[132:135]
    v_rcp_f32 v92, v92
    v_mfma_f32_16x16x32_bf16 v[8:11], v[112:115], v[84:87], 0
    v_cvt_pk_bf16_f32 v225, v122, v123
    v_lshlrev_b32 v12, 16, v80
    v_mfma_f32_16x16x32_bf16 v[120:123], v[64:67], v[84:87], 0
    v_and_b32 v13, 0xffff0000, v80
    v_mul_f32 v28, v28, v92
    v_mfma_f32_16x16x32_bf16 v[24:27], v[224:227], v[16:19], v[24:27]
    v_mul_f32 v29, v29, v92
    v_mul_f32 v30, v30, v92
    v_mfma_f32_16x16x32_bf16 v[16:19], v[204:207], v[84:87], 0
    v_mul_f32 v31, v31, v92
    v_mul_f32 v132, v132, v92
    v_mfma_f32_16x16x16_bf16 v[96:99], v[88:89], v[70:71], v[96:99]
    v_mul_f32 v133, v133, v92
    v_mul_f32 v134, v134, v92
    v_mfma_f32_16x16x16_bf16 v[8:11], v[90:91], v[70:71], v[8:11]
    v_mul_f32 v135, v135, v92
    v_mul_f32 v24, v24, v92
    v_mfma_f32_16x16x16_bf16 v[120:123], v[68:69], v[70:71], v[120:123]
    v_mul_f32 v25, v25, v92
    v_mul_f32 v26, v26, v92
    v_mfma_f32_16x16x16_bf16 v[16:19], v[208:209], v[70:71], v[16:19]
    v_mul_f32 v27, v27, v92
    v_cvt_pk_bf16_f32 v28, v28, v29
    v_mfma_f32_16x16x32_bf16 v[84:87], v[128:131], v[36:39], 0
    v_cvt_pk_bf16_f32 v29, v30, v31
    v_cvt_pk_bf16_f32 v30, v132, v133
    v_mfma_f32_16x16x32_bf16 v[84:87], v[216:219], v[116:119], v[84:87]
    v_cvt_pk_bf16_f32 v31, v134, v135
    v_cvt_pk_bf16_f32 v24, v24, v25
    v_mfma_f32_16x16x32_bf16 v[92:95], v[100:103], v[36:39], 0
    ds_write_b128 v245, v[28:31] offset:44032
    v_mfma_f32_16x16x32_bf16 v[92:95], v[220:223], v[116:119], v[92:95]
    v_cvt_pk_bf16_f32 v25, v26, v27
    v_max3_f32 v16, v96, v97, v17
    v_mfma_f32_16x16x32_bf16 v[132:135], v[124:127], v[36:39], 0
    v_mul_f32 v84, v84, v0
    v_mul_f32 v85, v85, v0
    v_mfma_f32_16x16x32_bf16 v[132:135], v[224:227], v[116:119], v[132:135]
    ds_write_b64 v246, v[24:25] offset:44032
    v_mfma_f32_16x16x32_bf16 v[36:39], v[210:213], v[76:79], 0
    s_add_u32 s70, s39, 774144
    v_mul_f32 v86, v86, v0
    v_mul_f32 v87, v87, v0
    v_mfma_f32_16x16x32_bf16 v[116:119], v[210:213], v[112:115], 0
    s_add_u32 s71, s39, 860160
    v_mul_f32 v92, v92, v0
    v_mul_f32 v93, v93, v0
    v_mfma_f32_16x16x32_bf16 v[76:79], v[210:213], v[64:67], 0
    v_mul_f32 v94, v94, v0
    v_mul_f32 v95, v95, v0
    v_mfma_f32_16x16x32_bf16 v[112:115], v[210:213], v[204:207], 0
    v_mul_f32 v132, v132, v0
    v_mul_f32 v133, v133, v0
    v_mfma_f32_16x16x16_bf16 v[36:39], v[214:215], v[88:89], v[36:39]
    v_mul_f32 v134, v134, v0
    v_mul_f32 v135, v135, v0
    v_mfma_f32_16x16x16_bf16 v[116:119], v[214:215], v[90:91], v[116:119]
    v_cvt_pk_bf16_f32 v84, v84, v85
    v_cvt_pk_bf16_f32 v85, v86, v87
    v_mfma_f32_16x16x16_bf16 v[76:79], v[214:215], v[68:69], v[76:79]
    v_cvt_pk_bf16_f32 v86, v92, v93
    v_cvt_pk_bf16_f32 v87, v94, v95
    v_mfma_f32_16x16x16_bf16 v[112:115], v[214:215], v[208:209], v[112:115]
    ds_write_b128 v245, v[84:87] offset:50176
    v_mfma_f32_16x16x16_bf16 v[0:3], v[234:235], v[44:45], 0
    v_cvt_pk_bf16_f32 v132, v132, v133
    v_cvt_pk_bf16_f32 v133, v134, v135
    v_mfma_f32_16x16x16_bf16 v[84:87], v[234:235], v[46:47], 0
    v_max3_f32 v18, v98, v99, v8
    v_max3_f32 v16, v16, v9, v10
    v_mfma_f32_16x16x16_bf16 v[44:47], v[234:235], v[48:49], 0
    ds_write_b64 v246, v[132:133] offset:50176
    v_max3_f32 v18, v18, v11, v120
    v_max3_f32 v16, v16, v121, v122
    v_max3_f32 v16, v16, v18, v123
    v_mov_b32 v18, v16
    v_mov_b32 v114, 0xff800000
    v_cndmask_b32 v113, v114, v113, vcc
    v_permlane32_swap_b32 v16, v18
    v_max_f32 v16, v16, v18
    v_mov_b32 v18, v16
    v_mov_b32_dpp v113, v37 quad_perm:[0,1,2,3] row_mask:0x1 bank_mask:0xf
    v_lshlrev_b32 v14, 16, v81
    v_permlane16_swap_b32 v16, v18
    v_max_f32 v16, v16, v18
    v_mul_f32 v16, s44, v16
    v_fma_f32 v96, v96, s44, -v16
    v_fma_f32 v97, v97, s44, -v16
    v_fma_f32 v98, v98, s44, -v16
    v_fma_f32 v99, v99, s44, -v16
    s_waitcnt lgkmcnt(0)
    s_barrier
    v_fma_f32 v8, v8, s44, -v16
    v_fma_f32 v9, v9, s44, -v16
    v_fma_f32 v10, v10, s44, -v16
    v_fma_f32 v11, v11, s44, -v16
    ds_read_b128 v[132:135], v247 offset:44032
    ds_read_b128 v[36:39], v247 offset:45056
    ds_read_b128 v[56:59], v247 offset:46080
    ds_read_b128 v[60:63], v247 offset:50176
    ds_read_b128 v[28:31], v247 offset:47104
    ds_read_b128 v[24:27], v247 offset:51200
    ds_read_b128 v[64:67], v247 offset:48128
    v_fma_f32 v120, v120, s44, -v16
    v_fma_f32 v121, v121, s44, -v16
    v_fma_f32 v122, v122, s44, -v16
    v_fma_f32 v123, v123, s44, -v16
    v_fma_f32 v17, v17, s44, -v16
    v_exp_f32 v96, v96
    v_exp_f32 v97, v97
    v_exp_f32 v98, v98
    v_exp_f32 v99, v99
    v_exp_f32 v8, v8
    v_exp_f32 v9, v9
    s_waitcnt lgkmcnt(6)
    v_mfma_f32_16x16x32_bf16 v[0:3], a[216:219], v[132:135], v[0:3]
    ds_read_b128 v[68:71], v247 offset:52224
    s_waitcnt lgkmcnt(6)
    v_mfma_f32_16x16x32_bf16 v[0:3], a[228:231], v[36:39], v[0:3]
    ds_read_b128 v[88:91], v247 offset:49152
    s_waitcnt lgkmcnt(6)
    v_mfma_f32_16x16x32_bf16 v[0:3], a[240:243], v[56:59], v[0:3]
    v_exp_f32 v10, v10
    v_mfma_f32_16x16x32_bf16 v[84:87], a[220:223], v[132:135], v[84:87]
    s_waitcnt lgkmcnt(5)
    v_exp_f32 v11, v11
    v_mfma_f32_16x16x32_bf16 v[84:87], a[232:235], v[36:39], v[84:87]
    s_waitcnt lgkmcnt(4)
    v_exp_f32 v120, v120
    v_mfma_f32_16x16x32_bf16 v[84:87], a[244:247], v[56:59], v[84:87]
    s_waitcnt lgkmcnt(3)
    v_exp_f32 v121, v121
    v_mfma_f32_16x16x32_bf16 v[84:87], v[172:175], v[28:31], v[84:87]
    s_waitcnt lgkmcnt(2)
    v_exp_f32 v122, v122
    v_mfma_f32_16x16x32_bf16 v[84:87], v[184:187], v[64:67], v[84:87]
    s_waitcnt lgkmcnt(1)
    ds_read_b128 v[92:95], v247 offset:53248
    s_waitcnt lgkmcnt(1)
    v_mfma_f32_16x16x32_bf16 v[84:87], v[196:199], v[88:91], v[84:87]
    v_exp_f32 v123, v123
    v_mfma_f32_16x16x32_bf16 v[44:47], a[224:227], v[132:135], v[44:47]
    ds_read_b128 v[132:135], v247 offset:54272
    v_exp_f32 v17, v17
    v_mfma_f32_16x16x32_bf16 v[44:47], a[236:239], v[36:39], v[44:47]
    ds_read_b128 v[36:39], v247 offset:55296
    v_cvt_pk_bf16_f32 v96, v96, v97
    v_mfma_f32_16x16x32_bf16 v[44:47], a[248:251], v[56:59], v[44:47]
    ds_read_b128 v[56:59], v247 offset:1024
    v_mov_b32_dpp v113, v117 quad_perm:[0,1,2,3] row_mask:0x2 bank_mask:0xf
    v_mfma_f32_16x16x32_bf16 v[44:47], v[176:179], v[28:31], v[44:47]
    ds_read_b128 v[116:119], v247 offset:2048
    v_cvt_pk_bf16_f32 v97, v98, v99
    v_mfma_f32_16x16x32_bf16 v[44:47], v[188:191], v[64:67], v[44:47]
    v_mov_b32_dpp v113, v77 quad_perm:[0,1,2,3] row_mask:0x4 bank_mask:0xf
    v_cvt_pk_bf16_f32 v98, v8, v9
    v_mfma_f32_16x16x32_bf16 v[44:47], v[200:203], v[88:91], v[44:47]
    s_waitcnt lgkmcnt(4)
    ds_read_b128 v[76:79], v247 offset:3072
    v_cvt_pk_bf16_f32 v99, v10, v11
    v_mfma_f32_16x16x32_bf16 v[0:3], a[252:255], v[28:31], v[0:3]
    v_cvt_pk_bf16_f32 v120, v120, v121
    v_cvt_pk_bf16_f32 v121, v122, v123
    v_mfma_f32_16x16x32_bf16 v[0:3], v[180:183], v[64:67], v[0:3]
    s_waitcnt lgkmcnt(4)
    v_cvt_pk_bf16_f32 v122, 0, v17
    v_mov_b32 v123, 0
    v_mfma_f32_16x16x32_bf16 v[0:3], v[192:195], v[88:91], v[0:3]
    s_waitcnt lgkmcnt(3)
    v_and_b32 v15, 0xffff0000, v81
    v_lshlrev_b32 v8, 16, v82
    v_mfma_f32_16x16x32_bf16 v[28:31], v[228:231], v[96:99], 0
    s_waitcnt lgkmcnt(2)
    v_and_b32 v9, 0xffff0000, v82
    v_lshlrev_b32 v10, 16, v83
    v_mfma_f32_16x16x32_bf16 v[28:31], v[230:233], v[120:123], v[28:31]
    s_waitcnt lgkmcnt(1)
    v_and_b32 v11, 0xffff0000, v83
    v_lshlrev_b32 v64, 16, v50
    v_mfma_f32_16x16x32_bf16 v[16:19], v[128:131], v[96:99], 0
    v_and_b32 v65, 0xffff0000, v50
    v_lshlrev_b32 v66, 16, v51
    v_mfma_f32_16x16x32_bf16 v[16:19], v[216:219], v[120:123], v[16:19]
    s_waitcnt lgkmcnt(0)
    v_and_b32 v67, 0xffff0000, v51
    v_cvt_pk_bf16_f32 v0, v0, v1
    v_mfma_f32_16x16x32_bf16 v[12:15], a[216:219], v[60:63], v[12:15]
    v_cvt_pk_bf16_f32 v1, v2, v3
    v_cvt_pk_bf16_f32 v84, v84, v85
    v_mfma_f32_16x16x32_bf16 v[12:15], a[228:231], v[24:27], v[12:15]
    ds_write_b64 v242, v[0:1] offset:0
    v_mfma_f32_16x16x32_bf16 v[12:15], a[240:243], v[68:71], v[12:15]
    v_cvt_pk_bf16_f32 v85, v86, v87
    v_rcp_f32 v28, v28
    v_mfma_f32_16x16x32_bf16 v[12:15], a[252:255], v[92:95], v[12:15]
    ds_write_b64 v242, v[84:85] offset:32
    v_mfma_f32_16x16x32_bf16 v[12:15], v[180:183], v[132:135], v[12:15]
    v_mul_f32 v16, v16, v28
    v_cvt_pk_bf16_f32 v44, v44, v45
    v_mfma_f32_16x16x32_bf16 v[12:15], v[192:195], v[36:39], v[12:15]
    v_mul_f32 v17, v17, v28
    v_cvt_pk_bf16_f32 v45, v46, v47
    v_mfma_f32_16x16x32_bf16 v[88:91], v[100:103], v[96:99], 0
    ds_write_b64 v242, v[44:45] offset:64
    v_mfma_f32_16x16x32_bf16 v[88:91], v[220:223], v[120:123], v[88:91]
    v_mul_f32 v18, v18, v28
    v_mul_f32 v19, v19, v28
    v_mfma_f32_16x16x32_bf16 v[48:51], v[124:127], v[96:99], 0
    v_cvt_pk_bf16_f32 v12, v12, v13
    v_cvt_pk_bf16_f32 v13, v14, v15
    v_mfma_f32_16x16x32_bf16 v[48:51], v[224:227], v[120:123], v[48:51]
    ds_write_b64 v243, v[12:13] offset:0
    v_mfma_f32_16x16x32_bf16 v[8:11], a[220:223], v[60:63], v[8:11]
    v_mul_f32 v88, v88, v28
    v_mul_f32 v89, v89, v28
    v_mfma_f32_16x16x32_bf16 v[8:11], a[232:235], v[24:27], v[8:11]
    v_mul_f32 v90, v90, v28
    v_mul_f32 v91, v91, v28
    v_mfma_f32_16x16x32_bf16 v[8:11], a[244:247], v[68:71], v[8:11]
    v_mul_f32 v48, v48, v28
    v_mul_f32 v49, v49, v28
    v_mfma_f32_16x16x32_bf16 v[8:11], v[172:175], v[92:95], v[8:11]
    v_mul_f32 v50, v50, v28
    v_mul_f32 v51, v51, v28
    v_mfma_f32_16x16x32_bf16 v[8:11], v[184:187], v[132:135], v[8:11]
    v_cvt_pk_bf16_f32 v16, v16, v17
    v_cvt_pk_bf16_f32 v17, v18, v19
    v_mfma_f32_16x16x32_bf16 v[8:11], v[196:199], v[36:39], v[8:11]
    v_cvt_pk_bf16_f32 v18, v88, v89
    v_cvt_pk_bf16_f32 v19, v90, v91
    v_mfma_f32_16x16x32_bf16 v[64:67], a[224:227], v[60:63], v[64:67]
    ds_write_b128 v245, v[16:19] offset:56320
    v_mfma_f32_16x16x32_bf16 v[64:67], a[236:239], v[24:27], v[64:67]
    v_cvt_pk_bf16_f32 v48, v48, v49
    v_cvt_pk_bf16_f32 v49, v50, v51
    v_mfma_f32_16x16x32_bf16 v[64:67], a[248:251], v[68:71], v[64:67]
    v_cvt_pk_bf16_f32 v8, v8, v9
    v_cvt_pk_bf16_f32 v9, v10, v11
    v_mfma_f32_16x16x32_bf16 v[64:67], v[176:179], v[92:95], v[64:67]
    ds_write_b64 v243, v[8:9] offset:32
    v_mfma_f32_16x16x32_bf16 v[64:67], v[188:191], v[132:135], v[64:67]
    v_mul_f32 v113, s44, v113
    v_lshlrev_b32 v0, 16, v72
    v_mfma_f32_16x16x32_bf16 v[64:67], v[200:203], v[36:39], v[64:67]
    ds_read_b128 v[44:47], v247 offset:4096
    ds_read_b128 v[96:99], v247 offset:5120
    v_mfma_f32_16x16x32_bf16 v[120:123], a[0:3], v[56:59], 0
    ds_read_b128 v[60:63], v247 offset:6144
    v_max_f32_dpp v114, v113, v113 row_ror:8 row_mask:0xf bank_mask:0xf
    v_mfma_f32_16x16x32_bf16 v[120:123], a[12:15], v[116:119], v[120:123]
    ds_write_b64 v246, v[48:49] offset:56320
    v_mfma_f32_16x16x32_bf16 v[120:123], a[24:27], v[76:79], v[120:123]
    v_cvt_pk_bf16_f32 v64, v64, v65
    v_cvt_pk_bf16_f32 v65, v66, v67
    v_mfma_f32_16x16x32_bf16 v[16:19], a[4:7], v[56:59], 0
    ds_write_b64 v243, v[64:65] offset:64
    v_mfma_f32_16x16x32_bf16 v[16:19], a[16:19], v[116:119], v[16:19]
    v_max_f32_dpp v114, v114, v114 row_ror:4 row_mask:0xf bank_mask:0xf
    v_and_b32 v1, 0xffff0000, v72
    v_mfma_f32_16x16x32_bf16 v[16:19], a[28:31], v[76:79], v[16:19]
    s_waitcnt lgkmcnt(4)
    v_max_f32_dpp v114, v114, v114 row_ror:2 row_mask:0xf bank_mask:0xf
    v_lshlrev_b32 v2, 16, v73
    v_mfma_f32_16x16x32_bf16 v[16:19], a[40:43], v[44:47], v[16:19]
    s_waitcnt lgkmcnt(3)
    v_max_f32_dpp v114, v114, v114 row_ror:1 row_mask:0xf bank_mask:0xf
    v_and_b32 v3, 0xffff0000, v73
    v_mfma_f32_16x16x32_bf16 v[16:19], a[52:55], v[96:99], v[16:19]
    s_waitcnt lgkmcnt(2)
    v_max_f32_dpp v114, v114, v114 row_bcast:15 row_mask:0xa bank_mask:0xf
    v_lshlrev_b32 v132, 16, v74
    v_mfma_f32_16x16x32_bf16 v[16:19], a[64:67], v[60:63], v[16:19]
    v_max_f32_dpp v114, v114, v114 row_bcast:31 row_mask:0xc bank_mask:0xf
    v_and_b32 v133, 0xffff0000, v74
    v_mfma_f32_16x16x32_bf16 v[36:39], a[8:11], v[56:59], 0
    s_waitcnt vmcnt(0) lgkmcnt(0)
    s_barrier
    v_mfma_f32_16x16x32_bf16 v[36:39], a[20:23], v[116:119], v[36:39]
    v_readlane_b32 s85, v114, 63
    v_lshlrev_b32 v134, 16, v75
    v_mfma_f32_16x16x32_bf16 v[36:39], a[32:35], v[76:79], v[36:39]
    ds_read_b128 v[48:51], v236 offset:30368
    ds_read_b128 v[56:59], v236 offset:30400
    v_mfma_f32_16x16x32_bf16 v[36:39], a[44:47], v[44:47], v[36:39]
    ds_read_b128 v[116:119], v236 offset:30432
    ds_read_b128 v[80:83], v236 offset:26208
    v_mfma_f32_16x16x32_bf16 v[36:39], a[56:59], v[96:99], v[36:39]
    ds_read_b128 v[84:87], v236 offset:29952
    ds_read_b128 v[76:79], v247 offset:56320
    v_mfma_f32_16x16x32_bf16 v[36:39], a[68:71], v[60:63], v[36:39]
    ds_read_b128 v[24:27], v236 offset:26240
    ds_read_b128 v[28:31], v236 offset:29984
    v_mfma_f32_16x16x32_bf16 v[120:123], a[36:39], v[44:47], v[120:123]
    ds_read_b128 v[44:47], v247 offset:57344
    ds_read_b128 v[88:91], v236 offset:26272
    v_mfma_f32_16x16x32_bf16 v[120:123], a[48:51], v[96:99], v[120:123]
    ds_read_b128 v[96:99], v247 offset:58368
    ds_read_b128 v[92:95], v236 offset:30016
    v_mfma_f32_16x16x32_bf16 v[120:123], a[60:63], v[60:63], v[120:123]
    ds_read_b128 v[8:11], v236 offset:33696
    s_waitcnt lgkmcnt(12)
    v_mfma_f32_16x16x32_bf16 v[60:63], v[136:139], v[48:51], 0
    ds_read_b128 v[12:15], v239 offset:27040
    s_waitcnt lgkmcnt(12)
    v_mfma_f32_16x16x32_bf16 v[48:51], v[148:151], v[56:59], 0
    ds_read_b128 v[64:67], v236 offset:33728
    s_waitcnt lgkmcnt(12)
    v_mfma_f32_16x16x32_bf16 v[56:59], v[160:163], v[116:119], 0
    ds_read_b128 v[68:71], v239 offset:27072
    ds_read_b128 v[116:119], v247 offset:59392
    v_cvt_pk_bf16_f32 v120, v120, v121
    s_waitcnt lgkmcnt(12)
    v_smfmac_f32_16x16x64_bf16 v[60:63], v[140:143], v[80:87], v255
    ds_read_b128 v[80:83], v236 offset:33760
    s_waitcnt lgkmcnt(12)
    v_mfma_f32_16x16x32_bf16 v[0:3], a[216:219], v[76:79], v[0:3]
    ds_read_b128 v[84:87], v239 offset:27104
    v_cvt_pk_bf16_f32 v121, v122, v123
    v_subrev_f32 v113, s85, v113
    v_and_b32 v135, 0xffff0000, v75
    s_waitcnt lgkmcnt(11)
    v_smfmac_f32_16x16x64_bf16 v[48:51], v[152:155], v[24:31], v255
    ds_read_b128 v[72:75], v247 offset:60416
    s_waitcnt lgkmcnt(11)
    v_mfma_f32_16x16x32_bf16 v[0:3], a[228:231], v[44:47], v[0:3]
    ds_read_b128 v[24:27], v247 offset:61440
    v_exp_f32 v113, v113
    v_mfma_f32_16x16x32_bf16 v[132:135], a[220:223], v[76:79], v[132:135]
    s_waitcnt lgkmcnt(11)
    v_lshlrev_b32 v28, 16, v52
    v_add_f32_dpp v114, v113, v113 row_ror:8 row_mask:0xf bank_mask:0xf
    v_mfma_f32_16x16x32_bf16 v[132:135], a[232:235], v[44:47], v[132:135]
    s_waitcnt lgkmcnt(10)
    v_and_b32 v29, 0xffff0000, v52
    v_add_f32_dpp v114, v114, v114 row_ror:4 row_mask:0xf bank_mask:0xf
    v_mfma_f32_16x16x32_bf16 v[132:135], a[244:247], v[96:99], v[132:135]
    s_waitcnt lgkmcnt(9)
    v_lshlrev_b32 v30, 16, v53
    v_cvt_pk_bf16_f32 v122, v16, v17
    v_mfma_f32_16x16x32_bf16 v[0:3], a[240:243], v[96:99], v[0:3]
    s_waitcnt lgkmcnt(8)
    v_add_f32_dpp v114, v114, v114 row_ror:2 row_mask:0xf bank_mask:0xf
    v_and_b32 v31, 0xffff0000, v53
    v_smfmac_f32_16x16x64_bf16 v[56:59], v[164:167], v[88:95], v255
    s_waitcnt lgkmcnt(7)
    ds_read_b128 v[52:55], v253 offset:0
    v_smfmac_f32_16x16x64_bf16 v[60:63], v[144:147], v[8:15], v255
    s_waitcnt lgkmcnt(7)
    ds_read_b128 v[88:91], v253 offset:2800
    v_mfma_f32_16x16x32_bf16 v[28:31], a[224:227], v[76:79], v[28:31]
    s_waitcnt lgkmcnt(7)
    ds_read_b128 v[92:95], v253 offset:5600
    ds_read_b128 v[76:79], v253 offset:8400
    v_mfma_f32_16x16x32_bf16 v[28:31], a[236:239], v[44:47], v[28:31]
    s_waitcnt lgkmcnt(8)
    v_cvt_pk_bf16_f32 v123, v18, v19
    v_add_f32_dpp v114, v114, v114 row_ror:1 row_mask:0xf bank_mask:0xf
    v_mfma_f32_16x16x32_bf16 v[28:31], a[248:251], v[96:99], v[28:31]
    s_waitcnt lgkmcnt(7)
    v_add_f32_dpp v114, v114, v114 row_bcast:15 row_mask:0xa bank_mask:0xf
    v_cvt_pk_bf16_f32 v36, v36, v37
    v_mfma_f32_16x16x32_bf16 v[28:31], v[176:179], v[116:119], v[28:31]
    s_waitcnt lgkmcnt(6)
    ds_read_b128 v[44:47], v237 offset:30368
    s_waitcnt lgkmcnt(6)
    v_mfma_f32_16x16x32_bf16 v[28:31], v[188:191], v[72:75], v[28:31]
    ds_read_b128 v[16:19], v237 offset:30400
    s_waitcnt lgkmcnt(6)
    v_mfma_f32_16x16x32_bf16 v[28:31], v[200:203], v[24:27], v[28:31]
    ds_read_b128 v[96:99], v237 offset:30432
    s_waitcnt lgkmcnt(6)
    buffer_store_dwordx4 v[52:55], v254, s[32:35], s68 offen nt
    v_smfmac_f32_16x16x64_bf16 v[48:51], v[156:159], v[64:71], v255
    s_waitcnt lgkmcnt(4)
    s_add_u32 s68, s39, 946176
    ds_read_b128 v[8:11], v237 offset:26208
    v_mfma_f32_16x16x32_bf16 v[0:3], a[252:255], v[116:119], v[0:3]
    s_waitcnt lgkmcnt(4)
    ds_read_b128 v[12:15], v237 offset:29952
    ds_read_b128 v[64:67], v237 offset:26240
    v_mfma_f32_16x16x32_bf16 v[0:3], v[180:183], v[72:75], v[0:3]
    s_waitcnt lgkmcnt(5)
    ds_read_b128 v[68:71], v237 offset:29984
    v_add_f32_dpp v114, v114, v114 row_bcast:31 row_mask:0xc bank_mask:0xf
    v_mfma_f32_16x16x32_bf16 v[0:3], v[192:195], v[24:27], v[0:3]
    s_waitcnt lgkmcnt(5)
    v_readlane_b32 s85, v114, 63
    v_cvt_pk_bf16_f32 v37, v38, v39
    v_smfmac_f32_16x16x64_bf16 v[56:59], v[168:171], v[80:87], v255
    s_waitcnt lgkmcnt(4)
    ds_read_b128 v[80:83], v237 offset:26272
    v_mfma_f32_16x16x32_bf16 v[132:135], v[172:175], v[116:119], v[132:135]
    ds_read_b128 v[84:87], v237 offset:30016
    v_rcp_f32 v114, s85
    v_mfma_f32_16x16x32_bf16 v[132:135], v[184:187], v[72:75], v[132:135]
    buffer_store_dwordx4 v[88:91], v254, s[32:35], s69 offen nt
    v_mfma_f32_16x16x32_bf16 v[132:135], v[196:199], v[24:27], v[132:135]
    s_waitcnt lgkmcnt(4)
    v_mul_f32 v113, v113, v114
    v_cvt_pk_bf16_f32 v113, v113, v113
    v_mfma_f32_16x16x32_bf16 v[52:55], v[136:139], v[44:47], 0
    s_waitcnt lgkmcnt(3)
    ds_write_b16 v104, v113 offset:0
    v_mfma_f32_16x16x32_bf16 v[72:75], v[148:151], v[16:19], 0
    s_waitcnt lgkmcnt(3)
    ds_read_b128 v[88:91], v105 offset:0
    ds_read_b128 v[24:27], v105 offset:64
    v_mfma_f32_16x16x32_bf16 v[44:47], v[160:163], v[96:99], 0
    s_waitcnt lgkmcnt(4)
    ds_read_b128 v[112:115], v237 offset:33696
    ds_read_b128 v[116:119], v240 offset:27040
    v_smfmac_f32_16x16x64_bf16 v[52:55], v[140:143], v[8:15], v255
    s_waitcnt lgkmcnt(5)
    s_add_u32 s69, s39, 1032192
    ds_read_b128 v[8:11], v237 offset:33728
    v_smfmac_f32_16x16x64_bf16 v[72:75], v[152:155], v[64:71], v255
    ds_read_b128 v[12:15], v240 offset:27072
    v_smfmac_f32_16x16x64_bf16 v[44:47], v[164:167], v[80:87], v255
    ds_read_b128 v[64:67], v237 offset:33760
    ds_read_b128 v[68:71], v240 offset:27104
    ds_read_b128 v[16:19], v238 offset:30368
    ds_read_b128 v[96:99], v238 offset:30400
    buffer_store_dwordx4 v[92:95], v254, s[32:35], s70 offen nt
    v_cvt_pk_bf16_f32 v0, v0, v1
    v_cvt_pk_bf16_f32 v1, v2, v3
    s_waitcnt lgkmcnt(8)
    v_mfma_f32_16x16x32_bf16 v[92:95], v[128:131], v[88:91], 0
    ds_read_b128 v[128:131], v238 offset:30432
    v_cvt_pk_bf16_f32 v132, v132, v133
    v_mfma_f32_16x16x32_bf16 v[92:95], v[216:219], v[24:27], v[92:95]
    s_waitcnt lgkmcnt(8)
    ds_read_b128 v[80:83], v238 offset:26208
    s_waitcnt lgkmcnt(8)
    v_smfmac_f32_16x16x64_bf16 v[52:55], v[144:147], v[112:119], v255
    ds_read_b128 v[84:87], v238 offset:29952
    v_mfma_f32_16x16x32_bf16 v[112:115], v[100:103], v[88:91], 0
    s_waitcnt lgkmcnt(8)
    ds_write_b64 v244, v[0:1] offset:0
    v_mfma_f32_16x16x32_bf16 v[112:115], v[220:223], v[24:27], v[112:115]
    s_waitcnt lgkmcnt(8)
    v_cvt_pk_bf16_f32 v92, v92, v93
    v_cvt_pk_bf16_f32 v93, v94, v95
    v_smfmac_f32_16x16x64_bf16 v[72:75], v[156:159], v[8:15], v255
    s_waitcnt lgkmcnt(7)
    s_waitcnt lgkmcnt(6)
    ds_read_b128 v[8:11], v238 offset:26240
    v_smfmac_f32_16x16x64_bf16 v[44:47], v[168:171], v[64:71], v255
    ds_read_b128 v[12:15], v238 offset:29984
    v_mfma_f32_16x16x32_bf16 v[116:119], v[124:127], v[88:91], 0
    s_waitcnt lgkmcnt(7)
    ds_read_b128 v[64:67], v238 offset:26272
    ds_read_b128 v[68:71], v238 offset:30016
    v_mfma_f32_16x16x32_bf16 v[116:119], v[224:227], v[24:27], v[116:119]
    s_waitcnt lgkmcnt(8)
    ds_read_b128 v[100:103], v247 offset:7168
    ds_read_b128 v[0:3], v247 offset:8192
    v_mfma_f32_16x16x32_bf16 v[88:91], v[136:139], v[16:19], 0
    s_waitcnt lgkmcnt(9)
    ds_read_b128 v[124:127], v247 offset:9216
    buffer_store_dwordx4 v[76:79], v254, s[32:35], s71 offen nt
    v_mfma_f32_16x16x32_bf16 v[24:27], v[148:151], v[96:99], 0
    s_waitcnt lgkmcnt(7)
    v_cvt_pk_bf16_f32 v94, v112, v113
    v_cvt_pk_bf16_f32 v95, v114, v115
    v_mfma_f32_16x16x32_bf16 v[16:19], v[160:163], v[128:131], 0
    s_waitcnt lgkmcnt(6)
    v_cvt_pk_bf16_f32 v116, v116, v117
    v_cvt_pk_bf16_f32 v117, v118, v119
    v_smfmac_f32_16x16x64_bf16 v[88:91], v[140:143], v[80:87], v255
    s_waitcnt lgkmcnt(5)
    ds_read_b128 v[80:83], v238 offset:33696
    v_smfmac_f32_16x16x64_bf16 v[24:27], v[152:155], v[8:15], v255
    s_waitcnt lgkmcnt(5)
    ds_read_b128 v[84:87], v241 offset:27040
    s_waitcnt lgkmcnt(5)
    v_smfmac_f32_16x16x64_bf16 v[16:19], v[164:167], v[64:71], v255
    ds_read_b128 v[8:11], v238 offset:33728
    s_waitcnt lgkmcnt(5)
    v_mfma_f32_16x16x32_bf16 v[76:79], a[0:3], v[100:103], 0
    ds_read_b128 v[12:15], v241 offset:27072
    s_waitcnt lgkmcnt(5)
    v_mfma_f32_16x16x32_bf16 v[76:79], a[12:15], v[0:3], v[76:79]
    ds_read_b128 v[64:67], v238 offset:33760
    s_waitcnt lgkmcnt(5)
    v_mfma_f32_16x16x32_bf16 v[76:79], a[24:27], v[124:127], v[76:79]
    ds_read_b128 v[68:71], v241 offset:27104
    ds_read_b128 v[96:99], v247 offset:10240
    v_mfma_f32_16x16x32_bf16 v[112:115], a[4:7], v[100:103], 0
    s_mov_b64 exec, s[62:63]
    ds_write_b128 v250, v[92:95] offset:1536
    ds_write_b64 v251, v[116:117] offset:1536
    s_mov_b64 exec, -1
    v_mfma_f32_16x16x32_bf16 v[112:115], a[16:19], v[0:3], v[112:115]
    s_waitcnt lgkmcnt(4)
    v_cvt_pk_bf16_f32 v133, v134, v135
    v_cvt_pk_bf16_f32 v28, v28, v29
    v_mfma_f32_16x16x32_bf16 v[112:115], a[28:31], v[124:127], v[112:115]
    s_waitcnt lgkmcnt(3)
    ds_write_b64 v244, v[132:133] offset:32
    s_waitcnt lgkmcnt(3)
    v_mfma_f32_16x16x32_bf16 v[112:115], a[40:43], v[96:99], v[112:115]
    s_add_u32 s70, s39, 1118208
    v_cvt_pk_bf16_f32 v29, v30, v31
    v_cvt_pk_bf16_f32 v116, v60, v61
    v_smfmac_f32_16x16x64_bf16 v[88:91], v[144:147], v[80:87], v255
    ds_read_b128 v[92:95], v247 offset:13312
    v_smfmac_f32_16x16x64_bf16 v[24:27], v[156:159], v[8:15], v255
    ds_read_b128 v[128:131], v247 offset:11264
    v_smfmac_f32_16x16x64_bf16 v[16:19], v[168:171], v[64:71], v255
    ds_read_b128 v[132:135], v247 offset:14336
    v_mfma_f32_16x16x32_bf16 v[168:171], a[8:11], v[100:103], 0
    ds_read_b128 v[100:103], v247 offset:12288
    ds_read_b128 v[80:83], v247 offset:15360
    v_mfma_f32_16x16x32_bf16 v[168:171], a[20:23], v[0:3], v[168:171]
    ds_write_b64 v244, v[28:29] offset:64
    v_mfma_f32_16x16x32_bf16 v[168:171], a[32:35], v[124:127], v[168:171]
    v_cvt_pk_bf16_f32 v84, v88, v89
    v_cvt_pk_bf16_f32 v85, v90, v91
    v_mfma_f32_16x16x32_bf16 v[168:171], a[44:47], v[96:99], v[168:171]
    v_cvt_pk_bf16_f32 v86, v24, v25
    v_cvt_pk_bf16_f32 v87, v26, v27
    v_mfma_f32_16x16x32_bf16 v[76:79], a[36:39], v[96:99], v[76:79]
    s_waitcnt lgkmcnt(5)
    s_waitcnt lgkmcnt(4)
    v_cvt_pk_bf16_f32 v0, v16, v17
    v_mfma_f32_16x16x32_bf16 v[76:79], a[48:51], v[128:131], v[76:79]
    v_cvt_pk_bf16_f32 v1, v18, v19
    v_cvt_pk_bf16_f32 v117, v62, v63
    v_mfma_f32_16x16x32_bf16 v[28:31], v[84:87], v[84:87], 0
    s_waitcnt lgkmcnt(3)
    v_cvt_pk_bf16_f32 v118, v48, v49
    v_cvt_pk_bf16_f32 v119, v50, v51
    v_mfma_f32_16x16x32_bf16 v[124:127], v[228:231], v[84:87], 0
    s_waitcnt lgkmcnt(2)
    v_cvt_pk_bf16_f32 v96, v56, v57
    v_cvt_pk_bf16_f32 v97, v58, v59
    v_mfma_f32_16x16x32_bf16 v[8:11], v[116:119], v[116:119], 0
    s_waitcnt lgkmcnt(1)
    v_cvt_pk_bf16_f32 v12, v52, v53
    v_cvt_pk_bf16_f32 v13, v54, v55
    v_mfma_f32_16x16x16_bf16 v[28:31], v[0:1], v[0:1], v[28:31]
    v_cvt_pk_bf16_f32 v14, v72, v73
    v_cvt_pk_bf16_f32 v15, v74, v75
    v_mfma_f32_16x16x16_bf16 v[124:127], v[228:229], v[0:1], v[124:127]
    v_cvt_pk_bf16_f32 v98, v44, v45
    v_cvt_pk_bf16_f32 v99, v46, v47
    v_mfma_f32_16x16x32_bf16 v[64:67], v[228:231], v[116:119], 0
    v_mfma_f32_16x16x16_bf16 v[8:11], v[96:97], v[96:97], v[8:11]
    v_mfma_f32_16x16x32_bf16 v[68:71], v[12:15], v[12:15], 0
    v_cndmask_b32 v28, v28, v29, s[52:53]
    v_cndmask_b32 v28, v28, v30, s[54:55]
    v_mfma_f32_16x16x32_bf16 v[136:139], v[228:231], v[12:15], 0
    v_cndmask_b32 v125, v28, v31, s[56:57]
    ds_write_b64 v249, v[124:125] offset:512
    v_mfma_f32_16x16x16_bf16 v[64:67], v[228:229], v[96:97], v[64:67]
    v_mfma_f32_16x16x16_bf16 v[68:71], v[98:99], v[98:99], v[68:71]
    v_cndmask_b32 v8, v8, v9, s[52:53]
    v_cndmask_b32 v8, v8, v10, s[54:55]
    v_mfma_f32_16x16x16_bf16 v[136:139], v[228:229], v[98:99], v[136:139]
    v_mfma_f32_16x16x32_bf16 v[140:143], a[0:3], v[92:95], 0
    v_mfma_f32_16x16x32_bf16 v[140:143], a[12:15], v[132:135], v[140:143]
    v_mfma_f32_16x16x32_bf16 v[140:143], a[24:27], v[80:83], v[140:143]
    ds_read_b128 v[28:31], v247 offset:16384
    v_cndmask_b32 v65, v8, v11, s[56:57]
    v_mfma_f32_16x16x32_bf16 v[76:79], a[60:63], v[100:103], v[76:79]
    ds_write_b64 v249, v[64:65] offset:0
    v_mfma_f32_16x16x32_bf16 v[124:127], a[4:7], v[92:95], 0
    v_cndmask_b32 v68, v68, v69, s[52:53]
    v_cndmask_b32 v68, v68, v70, s[54:55]
    v_mfma_f32_16x16x32_bf16 v[124:127], a[16:19], v[132:135], v[124:127]
    ds_read_b128 v[8:11], v247 offset:17408
    ds_read_b128 v[64:67], v247 offset:18432
    v_mfma_f32_16x16x32_bf16 v[124:127], a[28:31], v[80:83], v[124:127]
    v_cndmask_b32 v137, v68, v71, s[56:57]
    v_cvt_pk_bf16_f32 v76, v76, v77
    v_mfma_f32_16x16x32_bf16 v[112:115], a[52:55], v[128:131], v[112:115]
    ds_write_b64 v249, v[136:137] offset:256
    v_mfma_f32_16x16x32_bf16 v[112:115], a[64:67], v[100:103], v[112:115]
    s_waitcnt lgkmcnt(4)
    v_cvt_pk_bf16_f32 v77, v78, v79
    v_mfma_f32_16x16x32_bf16 v[68:71], a[8:11], v[92:95], 0
    v_mfma_f32_16x16x32_bf16 v[68:71], a[20:23], v[132:135], v[68:71]
    v_mfma_f32_16x16x32_bf16 v[68:71], a[32:35], v[80:83], v[68:71]
    v_mfma_f32_16x16x32_bf16 v[68:71], a[44:47], v[28:31], v[68:71]
    s_waitcnt lgkmcnt(2)
    ds_read_b128 v[136:139], v247 offset:1024
    v_cvt_pk_bf16_f32 v78, v112, v113
    v_mfma_f32_16x16x32_bf16 v[68:71], a[56:59], v[8:11], v[68:71]
    s_waitcnt lgkmcnt(2)
    ds_read_b128 v[92:95], v247 offset:2048
    s_waitcnt lgkmcnt(2)
    s_barrier
    v_mfma_f32_16x16x32_bf16 v[68:71], a[68:71], v[64:67], v[68:71]
    ds_read_b128 v[132:135], v247 offset:3072
    v_cvt_pk_bf16_f32 v79, v114, v115
    v_mfma_f32_16x16x32_bf16 v[168:171], a[56:59], v[128:131], v[168:171]
    ds_read_b128 v[80:83], v247 offset:23552
    ds_read_b128 v[112:115], v247 offset:24576
    v_mfma_f32_16x16x32_bf16 v[168:171], a[68:71], v[100:103], v[168:171]
    ds_read_b128 v[128:131], v247 offset:4096
    ds_read_b128 v[100:103], v247 offset:5120
    v_mfma_f32_16x16x32_bf16 v[140:143], a[36:39], v[28:31], v[140:143]
    ds_read_b128 v[144:147], v247 offset:6144
    ds_read_b128 v[148:151], v253 offset:11200
    v_mfma_f32_16x16x32_bf16 v[140:143], a[48:51], v[8:11], v[140:143]
    ds_read_b128 v[152:155], v253 offset:14000
    ds_read_b128 v[156:159], v253 offset:16800
    v_mfma_f32_16x16x32_bf16 v[140:143], a[60:63], v[64:67], v[140:143]
    s_waitcnt lgkmcnt(10)
    v_cvt_pk_bf16_f32 v38, v168, v169
    v_cvt_pk_bf16_f32 v39, v170, v171
    v_mfma_f32_16x16x32_bf16 v[124:127], a[40:43], v[28:31], v[124:127]
    s_waitcnt lgkmcnt(9)
    v_cvt_pk_bf16_f32 v68, v68, v69
    v_cvt_pk_bf16_f32 v69, v70, v71
    v_mfma_f32_16x16x32_bf16 v[124:127], a[52:55], v[8:11], v[124:127]
    s_waitcnt lgkmcnt(8)
    s_waitcnt lgkmcnt(7)
    v_add_f32 v80, v80, v82
    v_mfma_f32_16x16x32_bf16 v[124:127], a[64:67], v[64:67], v[124:127]
    s_mov_b32 vcc_lo, 0
    v_add_f32 v81, v81, v83
    s_waitcnt lgkmcnt(6)
    v_add_f32 v112, v112, v114
    v_mfma_f32_16x16x32_bf16 v[168:171], a[144:147], v[136:139], 0
    s_mov_b32 vcc_hi, 0x40000
    v_add_f32 v113, v113, v115
    v_add_f32 v80, v80, v112
    v_mfma_f32_16x16x32_bf16 v[168:171], a[156:159], v[92:95], v[168:171]
    s_waitcnt lgkmcnt(5)
    v_add_f32 v81, v81, v113
    v_mul_f32 v82, s45, v80
    v_mfma_f32_16x16x32_bf16 v[168:171], a[168:171], v[132:135], v[168:171]
    s_waitcnt lgkmcnt(4)
    v_mul_f32 v81, s45, v81
    v_fma_f32 v81, -v82, v82, v81
    v_mfma_f32_16x16x32_bf16 v[168:171], a[180:183], v[128:131], v[168:171]
    s_waitcnt lgkmcnt(3)
    s_waitcnt lgkmcnt(2)
    buffer_store_dwordx4 v[148:151], v254, s[32:35], s68 offen nt
    v_mfma_f32_16x16x32_bf16 v[168:171], a[192:195], v[100:103], v[168:171]
    s_waitcnt lgkmcnt(0)
    v_max_f32 v81, 0, v81
    v_add_f32 v81, s46, v81
    v_mfma_f32_16x16x32_bf16 v[168:171], a[204:207], v[144:147], v[168:171]
    v_rsq_f32 v80, v81
    v_mfma_f32_16x16x32_bf16 v[28:31], a[148:151], v[136:139], 0
    v_mul_f32 v81, -v82, v80
    v_cvt_pk_bf16_f32 v140, v140, v141
    v_mfma_f32_16x16x32_bf16 v[28:31], a[160:163], v[92:95], v[28:31]
    ds_write_b64 v245, v[80:81] offset:19456
    v_mfma_f32_16x16x32_bf16 v[28:31], a[172:175], v[132:135], v[28:31]
    v_cvt_pk_bf16_f32 v141, v142, v143
    v_cvt_pk_bf16_f32 v142, v124, v125
    v_mfma_f32_16x16x32_bf16 v[28:31], a[184:187], v[128:131], v[28:31]
    ds_read_b64 v[112:113], v248 offset:0
    ds_read_b64 v[114:115], v248 offset:256
    v_mfma_f32_16x16x32_bf16 v[28:31], a[196:199], v[100:103], v[28:31]
    ds_read_b64 v[82:83], v248 offset:512
    ds_read_b128 v[8:11], v247 offset:7168
    v_mfma_f32_16x16x32_bf16 v[28:31], a[208:211], v[144:147], v[28:31]
    buffer_store_dwordx4 v[152:155], v254, s[32:35], s69 offen nt
    v_mfma_f32_16x16x32_bf16 v[64:67], a[152:155], v[136:139], 0
    v_cvt_pk_bf16_f32 v143, v126, v127
    v_cvt_pk_bf16_f32 v168, v168, v169
    v_mfma_f32_16x16x32_bf16 v[64:67], a[164:167], v[92:95], v[64:67]
    ds_read_b128 v[148:151], v247 offset:8192
    v_cvt_pk_bf16_f32 v169, v170, v171
    v_mfma_f32_16x16x32_bf16 v[64:67], a[176:179], v[132:135], v[64:67]
    s_waitcnt lgkmcnt(4)
    v_cvt_pk_bf16_f32 v170, v28, v29
    v_cvt_pk_bf16_f32 v171, v30, v31
    v_mfma_f32_16x16x32_bf16 v[64:67], a[188:191], v[128:131], v[64:67]
    s_waitcnt lgkmcnt(2)
    v_fma_f32 v52, v52, v114, v115
    v_fma_f32 v53, v53, v114, v115
    v_mfma_f32_16x16x32_bf16 v[64:67], a[200:203], v[100:103], v[64:67]
    s_waitcnt lgkmcnt(1)
    v_fma_f32 v54, v54, v114, v115
    v_fma_f32 v55, v55, v114, v115
    v_mfma_f32_16x16x32_bf16 v[64:67], a[212:215], v[144:147], v[64:67]
    v_fma_f32 v72, v72, v114, v115
    v_fma_f32 v73, v73, v114, v115
    v_mfma_f32_16x16x32_bf16 v[152:155], v[120:123], v[168:171], 0
    v_fma_f32 v74, v74, v114, v115
    v_fma_f32 v75, v75, v114, v115
    v_mfma_f32_16x16x32_bf16 v[124:127], v[76:79], v[168:171], 0
    ds_read_b128 v[28:31], v247 offset:9216
    s_mov_b64 exec, s[48:49]
    buffer_store_dwordx4 v[156:159], v254, s[32:35], s70 offen nt
    s_mov_b64 exec, -1
    v_cvt_pk_bf16_f32 v70, v64, v65
    v_mfma_f32_16x16x32_bf16 v[156:159], v[140:143], v[168:171], 0
    s_waitcnt lgkmcnt(1)
    v_cvt_pk_bf16_f32 v71, v66, v67
    v_fma_f32 v44, v44, v114, v115
    v_mfma_f32_16x16x32_bf16 v[64:67], v[204:207], v[168:171], 0
    v_fma_f32 v45, v45, v114, v115
    v_fma_f32 v88, v88, v82, v83
    v_mfma_f32_16x16x16_bf16 v[152:155], v[36:37], v[70:71], v[152:155]
    v_fma_f32 v46, v46, v114, v115
    v_fma_f32 v89, v89, v82, v83
    v_mfma_f32_16x16x16_bf16 v[124:127], v[38:39], v[70:71], v[124:127]
    v_fma_f32 v47, v47, v114, v115
    v_fma_f32 v90, v90, v82, v83
    v_mfma_f32_16x16x16_bf16 v[156:159], v[68:69], v[70:71], v[156:159]
    s_waitcnt lgkmcnt(0)
    v_cvt_pk_bf16_f32 v52, v52, v53
    v_fma_f32 v91, v91, v82, v83
    v_mfma_f32_16x16x16_bf16 v[64:67], v[208:209], v[70:71], v[64:67]
    ds_read_b128 v[168:171], v247 offset:10240
    v_cvt_pk_bf16_f32 v53, v54, v55
    v_mfma_f32_16x16x32_bf16 v[160:163], v[136:139], a[72:75], 0
    v_fma_f32 v24, v24, v82, v83
    v_cvt_pk_bf16_f32 v54, v72, v73
    v_mfma_f32_16x16x32_bf16 v[160:163], v[92:95], a[84:87], v[160:163]
    v_fma_f32 v25, v25, v82, v83
    v_cvt_pk_bf16_f32 v55, v74, v75
    v_mfma_f32_16x16x32_bf16 v[160:163], v[132:135], a[96:99], v[160:163]
    ds_read_b128 v[164:167], v247 offset:11264
    v_fma_f32 v26, v26, v82, v83
    v_mfma_f32_16x16x32_bf16 v[160:163], v[128:131], a[108:111], v[160:163]
    v_cvt_pk_bf16_f32 v44, v44, v45
    v_fma_f32 v27, v27, v82, v83
    v_mfma_f32_16x16x32_bf16 v[160:163], v[100:103], a[120:123], v[160:163]
    v_cvt_pk_bf16_f32 v45, v46, v47
    v_fma_f32 v16, v16, v82, v83
    v_mfma_f32_16x16x32_bf16 v[160:163], v[144:147], a[132:135], v[160:163]
    ds_read_b128 v[72:75], v247 offset:12288
    v_fma_f32 v17, v17, v82, v83
    v_fma_f32 v18, v18, v82, v83
    v_fma_f32 v19, v19, v82, v83
    v_mfma_f32_16x16x32_bf16 v[80:83], a[144:147], v[8:11], 0
    s_waitcnt lgkmcnt(2)
    v_cvt_pk_bf16_f32 v88, v88, v89
    v_cvt_pk_bf16_f32 v89, v90, v91
    v_mfma_f32_16x16x32_bf16 v[80:83], a[156:159], v[148:151], v[80:83]
    v_cvt_pk_bf16_f32 v160, v160, v161
    v_cvt_pk_bf16_f32 v161, v162, v163
    v_mfma_f32_16x16x32_bf16 v[80:83], a[168:171], v[28:31], v[80:83]
    v_cvt_pk_bf16_f32 v90, v24, v25
    v_cvt_pk_bf16_f32 v91, v26, v27
    v_mfma_f32_16x16x32_bf16 v[80:83], a[180:183], v[168:171], v[80:83]
    s_waitcnt lgkmcnt(1)
    v_cvt_pk_bf16_f32 v16, v16, v17
    v_cvt_pk_bf16_f32 v17, v18, v19
    v_mfma_f32_16x16x32_bf16 v[80:83], a[192:195], v[164:167], v[80:83]
    s_waitcnt lgkmcnt(0)
    v_fma_f32 v60, v60, v112, v113
    v_mfma_f32_16x16x32_bf16 v[80:83], a[204:207], v[72:75], v[80:83]
    v_fma_f32 v61, v61, v112, v113
    v_fma_f32 v62, v62, v112, v113
    v_mfma_f32_16x16x32_bf16 v[24:27], v[136:139], a[76:79], 0
    v_fma_f32 v63, v63, v112, v113
    v_fma_f32 v48, v48, v112, v113
    v_mfma_f32_16x16x32_bf16 v[24:27], v[92:95], a[88:91], v[24:27]
    v_fma_f32 v49, v49, v112, v113
    v_fma_f32 v50, v50, v112, v113
    v_mfma_f32_16x16x32_bf16 v[24:27], v[132:135], a[100:103], v[24:27]
    v_cvt_pk_bf16_f32 v80, v80, v81
    v_cvt_pk_bf16_f32 v81, v82, v83
    v_mfma_f32_16x16x32_bf16 v[24:27], v[128:131], a[112:115], v[24:27]
    v_fma_f32 v51, v51, v112, v113
    v_fma_f32 v56, v56, v112, v113
    v_mfma_f32_16x16x32_bf16 v[24:27], v[100:103], a[124:127], v[24:27]
    v_fma_f32 v57, v57, v112, v113
    v_fma_f32 v58, v58, v112, v113
    v_mfma_f32_16x16x32_bf16 v[24:27], v[144:147], a[136:139], v[24:27]
    v_fma_f32 v59, v59, v112, v113
    v_cvt_pk_bf16_f32 v60, v60, v61
    v_mfma_f32_16x16x32_bf16 v[112:115], a[148:151], v[8:11], 0
    v_cvt_pk_bf16_f32 v61, v62, v63
    v_cvt_pk_bf16_f32 v62, v48, v49
    v_mfma_f32_16x16x32_bf16 v[112:115], a[160:163], v[148:151], v[112:115]
    v_cvt_pk_bf16_f32 v63, v50, v51
    v_cvt_pk_bf16_f32 v56, v56, v57
    v_mfma_f32_16x16x32_bf16 v[112:115], a[172:175], v[28:31], v[112:115]
    ds_write_b128 v245, v[60:63] offset:25600
    v_mfma_f32_16x16x32_bf16 v[112:115], a[184:187], v[168:171], v[112:115]
    v_cvt_pk_bf16_f32 v24, v24, v25
    v_cvt_pk_bf16_f32 v25, v26, v27
    v_mfma_f32_16x16x32_bf16 v[112:115], a[196:199], v[164:167], v[112:115]
    v_cvt_pk_bf16_f32 v57, v58, v59
    v_max3_f32 v64, v152, v153, v66
    v_mfma_f32_16x16x32_bf16 v[112:115], a[208:211], v[72:75], v[112:115]
    ds_write_b64 v246, v[56:57] offset:25600
    v_mfma_f32_16x16x32_bf16 v[48:51], v[136:139], a[80:83], 0
    v_max3_f32 v65, v154, v155, v124
    v_max3_f32 v64, v64, v125, v126
    v_mfma_f32_16x16x32_bf16 v[48:51], v[92:95], a[92:95], v[48:51]
    ds_write_b128 v245, v[52:55] offset:31744
    v_mfma_f32_16x16x32_bf16 v[48:51], v[132:135], a[104:107], v[48:51]
    v_max3_f32 v65, v65, v127, v156
    v_cvt_pk_bf16_f32 v82, v112, v113
    v_mfma_f32_16x16x32_bf16 v[48:51], v[128:131], a[116:119], v[48:51]
    v_cvt_pk_bf16_f32 v83, v114, v115
    v_max3_f32 v64, v64, v157, v158
    v_mfma_f32_16x16x32_bf16 v[48:51], v[100:103], a[128:131], v[48:51]
    ds_write_b64 v246, v[44:45] offset:31744
    v_mfma_f32_16x16x32_bf16 v[48:51], v[144:147], a[140:143], v[48:51]
    v_max3_f32 v64, v64, v65, v159
    v_mov_b32 v65, v64
    v_mfma_f32_16x16x32_bf16 v[136:139], v[120:123], v[80:83], 0
    ds_write_b128 v245, v[88:91] offset:37888
    v_mfma_f32_16x16x32_bf16 v[52:55], v[76:79], v[80:83], 0
    v_permlane32_swap_b32 v64, v65
    v_mfma_f32_16x16x32_bf16 v[112:115], v[140:143], v[80:83], 0
    v_max_f32 v64, v64, v65
    v_cvt_pk_bf16_f32 v48, v48, v49
    v_mfma_f32_16x16x32_bf16 v[100:103], v[204:207], v[80:83], 0
    ds_write_b64 v246, v[16:17] offset:37888
    v_mfma_f32_16x16x32_bf16 v[44:47], a[152:155], v[8:11], 0
    v_cvt_pk_bf16_f32 v49, v50, v51
    v_mov_b32 v65, v64
    v_mfma_f32_16x16x32_bf16 v[44:47], a[164:167], v[148:151], v[44:47]
    s_add_u32 s71, s39, 1204224
    v_permlane16_swap_b32 v64, v65
    v_mfma_f32_16x16x32_bf16 v[44:47], a[176:179], v[28:31], v[44:47]
    s_add_u32 s68, s39, 1290240
    v_max_f32 v64, v64, v65
    v_mul_f32 v64, s44, v64
    v_mfma_f32_16x16x32_bf16 v[44:47], a[188:191], v[168:171], v[44:47]
    v_fma_f32 v152, v152, s44, -v64
    v_fma_f32 v153, v153, s44, -v64
    v_mfma_f32_16x16x32_bf16 v[44:47], a[200:203], v[164:167], v[44:47]
    v_fma_f32 v154, v154, s44, -v64
    v_fma_f32 v155, v155, s44, -v64
    v_mfma_f32_16x16x32_bf16 v[44:47], a[212:215], v[72:75], v[44:47]
    v_fma_f32 v124, v124, s44, -v64
    v_fma_f32 v125, v125, s44, -v64
    v_mfma_f32_16x16x32_bf16 v[144:147], v[8:11], a[72:75], 0
    v_fma_f32 v126, v126, s44, -v64
    v_fma_f32 v127, v127, s44, -v64
    v_mfma_f32_16x16x32_bf16 v[144:147], v[148:151], a[84:87], v[144:147]
    v_fma_f32 v156, v156, s44, -v64
    v_fma_f32 v157, v157, s44, -v64
    v_mfma_f32_16x16x32_bf16 v[144:147], v[28:31], a[96:99], v[144:147]
    v_cvt_pk_bf16_f32 v70, v44, v45
    v_cvt_pk_bf16_f32 v71, v46, v47
    v_mfma_f32_16x16x32_bf16 v[144:147], v[168:171], a[108:111], v[144:147]
    v_fma_f32 v158, v158, s44, -v64
    v_fma_f32 v159, v159, s44, -v64
    v_mfma_f32_16x16x32_bf16 v[144:147], v[164:167], a[120:123], v[144:147]
    v_fma_f32 v66, v66, s44, -v64
    v_exp_f32 v152, v152
    v_mfma_f32_16x16x32_bf16 v[144:147], v[72:75], a[132:135], v[144:147]
    v_exp_f32 v153, v153
    v_mfma_f32_16x16x16_bf16 v[136:139], v[36:37], v[70:71], v[136:139]
    v_exp_f32 v154, v154
    v_mfma_f32_16x16x16_bf16 v[52:55], v[38:39], v[70:71], v[52:55]
    v_exp_f32 v155, v155
    v_mfma_f32_16x16x16_bf16 v[112:115], v[68:69], v[70:71], v[112:115]
    v_exp_f32 v124, v124
    v_mfma_f32_16x16x16_bf16 v[100:103], v[208:209], v[70:71], v[100:103]
    v_cvt_pk_bf16_f32 v162, v144, v145
    v_cvt_pk_bf16_f32 v163, v146, v147
    v_mfma_f32_16x16x32_bf16 v[80:83], v[8:11], a[76:79], 0
    v_exp_f32 v125, v125
    v_mfma_f32_16x16x32_bf16 v[80:83], v[148:151], a[88:91], v[80:83]
    ds_read_b128 v[16:19], v247 offset:13312
    v_exp_f32 v126, v126
    v_mfma_f32_16x16x32_bf16 v[80:83], v[28:31], a[100:103], v[80:83]
    ds_read_b128 v[44:47], v247 offset:14336
    v_max3_f32 v100, v136, v137, v102
    v_mfma_f32_16x16x32_bf16 v[80:83], v[168:171], a[112:115], v[80:83]
    ds_read_b128 v[144:147], v247 offset:15360
    v_max3_f32 v101, v138, v139, v52
    v_mfma_f32_16x16x32_bf16 v[80:83], v[164:167], a[124:127], v[80:83]
    ds_read_b128 v[60:63], v247 offset:16384
    v_max3_f32 v100, v100, v53, v54
    v_mfma_f32_16x16x32_bf16 v[80:83], v[72:75], a[136:139], v[80:83]
    ds_read_b128 v[56:59], v247 offset:17408
    v_max3_f32 v101, v101, v55, v112
    v_mfma_f32_16x16x32_bf16 v[92:95], v[8:11], a[80:83], 0
    ds_read_b128 v[88:91], v247 offset:18432
    v_max3_f32 v100, v100, v113, v114
    v_mfma_f32_16x16x32_bf16 v[92:95], v[148:151], a[92:95], v[92:95]
    v_max3_f32 v100, v100, v101, v115
    v_mov_b32 v101, v100
    v_mfma_f32_16x16x32_bf16 v[92:95], v[28:31], a[104:107], v[92:95]
    s_waitcnt lgkmcnt(5)
    v_cvt_pk_bf16_f32 v26, v80, v81
    v_cvt_pk_bf16_f32 v27, v82, v83
    v_mfma_f32_16x16x32_bf16 v[92:95], v[168:171], a[116:119], v[92:95]
    s_waitcnt lgkmcnt(4)
    v_permlane32_swap_b32 v100, v101
    v_mfma_f32_16x16x32_bf16 v[92:95], v[164:167], a[128:131], v[92:95]
    s_waitcnt lgkmcnt(3)
    v_max_f32 v100, v100, v101
    v_mov_b32 v101, v100
    v_mfma_f32_16x16x32_bf16 v[92:95], v[72:75], a[140:143], v[92:95]
    s_waitcnt lgkmcnt(2)
    v_permlane16_swap_b32 v100, v101
    v_mfma_f32_16x16x32_bf16 v[8:11], a[144:147], v[16:19], 0
    s_waitcnt lgkmcnt(1)
    v_max_f32 v100, v100, v101
    v_mul_f32 v100, s44, v100
    v_mfma_f32_16x16x32_bf16 v[8:11], a[156:159], v[44:47], v[8:11]
    s_waitcnt lgkmcnt(0)
    v_fma_f32 v136, v136, s44, -v100
    v_cvt_pk_bf16_f32 v50, v92, v93
    v_mfma_f32_16x16x32_bf16 v[8:11], a[168:171], v[144:147], v[8:11]
    v_cvt_pk_bf16_f32 v51, v94, v95
    v_fma_f32 v137, v137, s44, -v100
    v_mfma_f32_16x16x32_bf16 v[8:11], a[180:183], v[60:63], v[8:11]
    v_fma_f32 v138, v138, s44, -v100
    v_fma_f32 v139, v139, s44, -v100
    v_mfma_f32_16x16x32_bf16 v[8:11], a[192:195], v[56:59], v[8:11]
    v_fma_f32 v52, v52, s44, -v100
    v_fma_f32 v53, v53, s44, -v100
    v_mfma_f32_16x16x32_bf16 v[8:11], a[204:207], v[88:91], v[8:11]
    v_fma_f32 v54, v54, s44, -v100
    v_fma_f32 v55, v55, s44, -v100
    v_mfma_f32_16x16x32_bf16 v[148:151], a[148:151], v[16:19], 0
    v_fma_f32 v112, v112, s44, -v100
    v_fma_f32 v113, v113, s44, -v100
    v_mfma_f32_16x16x32_bf16 v[148:151], a[160:163], v[44:47], v[148:151]
    v_fma_f32 v114, v114, s44, -v100
    v_fma_f32 v115, v115, s44, -v100
    v_mfma_f32_16x16x32_bf16 v[148:151], a[172:175], v[144:147], v[148:151]
    v_fma_f32 v102, v102, s44, -v100
    v_exp_f32 v136, v136
    v_mfma_f32_16x16x32_bf16 v[148:151], a[184:187], v[60:63], v[148:151]
    v_exp_f32 v137, v137
    v_mfma_f32_16x16x32_bf16 v[148:151], a[196:199], v[56:59], v[148:151]
    v_exp_f32 v138, v138
    v_mfma_f32_16x16x32_bf16 v[148:151], a[208:211], v[88:91], v[148:151]
    v_exp_f32 v139, v139
    v_mfma_f32_16x16x32_bf16 v[28:31], a[152:155], v[16:19], 0
    v_exp_f32 v52, v52
    v_mfma_f32_16x16x32_bf16 v[28:31], a[164:167], v[44:47], v[28:31]
    v_exp_f32 v53, v53
    v_mfma_f32_16x16x32_bf16 v[28:31], a[176:179], v[144:147], v[28:31]
    v_exp_f32 v54, v54
    v_mfma_f32_16x16x32_bf16 v[28:31], a[188:191], v[60:63], v[28:31]
    v_exp_f32 v55, v55
    v_mfma_f32_16x16x32_bf16 v[28:31], a[200:203], v[56:59], v[28:31]
    v_exp_f32 v112, v112
    v_mfma_f32_16x16x32_bf16 v[28:31], a[212:215], v[88:91], v[28:31]
    v_exp_f32 v113, v113
    v_mfma_f32_16x16x32_bf16 v[80:83], v[16:19], a[72:75], 0
    v_exp_f32 v114, v114
    v_mfma_f32_16x16x32_bf16 v[80:83], v[44:47], a[84:87], v[80:83]
    v_exp_f32 v115, v115
    v_mfma_f32_16x16x32_bf16 v[80:83], v[144:147], a[96:99], v[80:83]
    v_exp_f32 v102, v102
    v_mfma_f32_16x16x32_bf16 v[80:83], v[60:63], a[108:111], v[80:83]
    v_cvt_pk_bf16_f32 v136, v136, v137
    v_cvt_pk_bf16_f32 v137, v138, v139
    v_mfma_f32_16x16x32_bf16 v[80:83], v[56:59], a[120:123], v[80:83]
    v_cvt_pk_bf16_f32 v138, v52, v53
    v_cvt_pk_bf16_f32 v139, v54, v55
    v_mfma_f32_16x16x32_bf16 v[80:83], v[88:91], a[132:135], v[80:83]
    v_cvt_pk_bf16_f32 v112, v112, v113
    v_cvt_pk_bf16_f32 v113, v114, v115
    v_mfma_f32_16x16x32_bf16 v[168:171], v[16:19], a[76:79], 0
    v_cvt_pk_bf16_f32 v115, v102, 0
    v_mov_b32 v114, 0
    v_mfma_f32_16x16x32_bf16 v[168:171], v[44:47], a[88:91], v[168:171]
    v_cvt_pk_bf16_f32 v8, v8, v9
    v_cvt_pk_bf16_f32 v9, v10, v11
    v_mfma_f32_16x16x32_bf16 v[168:171], v[144:147], a[100:103], v[168:171]
    v_cvt_pk_bf16_f32 v10, v148, v149
    v_cvt_pk_bf16_f32 v11, v150, v151
    v_mfma_f32_16x16x32_bf16 v[168:171], v[60:63], a[112:115], v[168:171]
    v_cvt_pk_bf16_f32 v70, v28, v29
    v_cvt_pk_bf16_f32 v71, v30, v31
    v_mfma_f32_16x16x32_bf16 v[168:171], v[56:59], a[124:127], v[168:171]
    v_cvt_pk_bf16_f32 v216, v80, v81
    v_cvt_pk_bf16_f32 v217, v82, v83
    v_mfma_f32_16x16x32_bf16 v[168:171], v[88:91], a[136:139], v[168:171]
    v_exp_f32 v127, v127
    v_mfma_f32_16x16x32_bf16 v[164:167], v[16:19], a[80:83], 0
    v_exp_f32 v156, v156
    v_mfma_f32_16x16x32_bf16 v[164:167], v[44:47], a[92:95], v[164:167]
    v_exp_f32 v157, v157
    v_mfma_f32_16x16x32_bf16 v[164:167], v[144:147], a[104:107], v[164:167]
    v_exp_f32 v158, v158
    v_mfma_f32_16x16x32_bf16 v[164:167], v[60:63], a[116:119], v[164:167]
    v_cvt_pk_bf16_f32 v220, v168, v169
    v_cvt_pk_bf16_f32 v221, v170, v171
    v_mfma_f32_16x16x32_bf16 v[164:167], v[56:59], a[128:131], v[164:167]
    v_exp_f32 v159, v159
    v_mfma_f32_16x16x32_bf16 v[164:167], v[88:91], a[140:143], v[164:167]
    v_exp_f32 v66, v66
    v_mfma_f32_16x16x32_bf16 v[72:75], v[228:231], v[136:139], 0
    v_cvt_pk_bf16_f32 v152, v152, v153
    v_cvt_pk_bf16_f32 v153, v154, v155
    v_mfma_f32_16x16x32_bf16 v[72:75], v[230:233], v[112:115], v[72:75]
    v_cvt_pk_bf16_f32 v154, v124, v125
    v_cvt_pk_bf16_f32 v155, v126, v127
    v_mfma_f32_16x16x32_bf16 v[52:55], v[160:163], v[136:139], 0
    v_cvt_pk_bf16_f32 v224, v164, v165
    v_cvt_pk_bf16_f32 v225, v166, v167
    v_mfma_f32_16x16x32_bf16 v[52:55], v[216:219], v[112:115], v[52:55]
    v_cvt_pk_bf16_f32 v156, v156, v157
    v_cvt_pk_bf16_f32 v157, v158, v159
    v_mfma_f32_16x16x32_bf16 v[100:103], v[24:27], v[136:139], 0
    v_cvt_pk_bf16_f32 v159, v66, 0
    v_mov_b32 v158, 0
    v_mfma_f32_16x16x32_bf16 v[100:103], v[220:223], v[112:115], v[100:103]
    s_add_u32 s69, s39, 1376256
    v_rcp_f32 v72, v72
    v_mfma_f32_16x16x32_bf16 v[28:31], v[48:51], v[136:139], 0
    s_add_u32 s70, s39, 1462272
    v_mul_f32 v52, v52, v72
    v_mul_f32 v53, v53, v72
    v_mfma_f32_16x16x32_bf16 v[28:31], v[224:227], v[112:115], v[28:31]
    v_mul_f32 v54, v54, v72
    v_mul_f32 v55, v55, v72
    v_mfma_f32_16x16x16_bf16 v[80:83], v[234:235], v[40:41], 0
    v_mul_f32 v100, v100, v72
    v_mul_f32 v101, v101, v72
    v_mfma_f32_16x16x16_bf16 v[16:19], v[234:235], v[42:43], 0
    v_mul_f32 v102, v102, v72
    v_mul_f32 v103, v103, v72
    v_mfma_f32_16x16x16_bf16 v[168:171], v[234:235], v[32:33], 0
    v_mul_f32 v28, v28, v72
    v_mul_f32 v29, v29, v72
    v_mfma_f32_16x16x32_bf16 v[124:127], v[228:231], v[152:155], 0
    v_mul_f32 v30, v30, v72
    v_mul_f32 v31, v31, v72
    v_mfma_f32_16x16x32_bf16 v[124:127], v[230:233], v[156:159], v[124:127]
    v_cvt_pk_bf16_f32 v52, v52, v53
    v_cvt_pk_bf16_f32 v53, v54, v55
    v_mfma_f32_16x16x32_bf16 v[164:167], v[160:163], v[152:155], 0
    v_cvt_pk_bf16_f32 v54, v100, v101
    v_cvt_pk_bf16_f32 v55, v102, v103
    v_mfma_f32_16x16x32_bf16 v[164:167], v[216:219], v[156:159], v[164:167]
    ds_write_b128 v245, v[52:55] offset:50176
    v_mfma_f32_16x16x32_bf16 v[64:67], v[24:27], v[152:155], 0
    v_rcp_f32 v124, v124
    v_mfma_f32_16x16x32_bf16 v[64:67], v[220:223], v[156:159], v[64:67]
    v_cvt_pk_bf16_f32 v28, v28, v29
    v_cvt_pk_bf16_f32 v29, v30, v31
    v_mfma_f32_16x16x32_bf16 v[136:139], v[48:51], v[152:155], 0
    ds_write_b64 v246, v[28:29] offset:50176
    v_mfma_f32_16x16x32_bf16 v[136:139], v[224:227], v[156:159], v[136:139]
    v_mul_f32 v164, v164, v124
    v_mul_f32 v165, v165, v124
    v_mfma_f32_16x16x32_bf16 v[112:115], v[120:123], v[8:11], 0
    v_mul_f32 v166, v166, v124
    v_mul_f32 v167, v167, v124
    v_mfma_f32_16x16x32_bf16 v[72:75], v[76:79], v[8:11], 0
    v_mul_f32 v64, v64, v124
    v_mul_f32 v65, v65, v124
    v_mfma_f32_16x16x32_bf16 v[100:103], v[140:143], v[8:11], 0
    v_mul_f32 v66, v66, v124
    v_mul_f32 v67, v67, v124
    v_mfma_f32_16x16x32_bf16 v[52:55], v[204:207], v[8:11], 0
    v_mul_f32 v136, v136, v124
    v_mul_f32 v137, v137, v124
    v_mfma_f32_16x16x16_bf16 v[112:115], v[36:37], v[70:71], v[112:115]
    v_mul_f32 v138, v138, v124
    v_mul_f32 v139, v139, v124
    v_mfma_f32_16x16x16_bf16 v[72:75], v[38:39], v[70:71], v[72:75]
    v_cvt_pk_bf16_f32 v164, v164, v165
    v_cvt_pk_bf16_f32 v165, v166, v167
    v_mfma_f32_16x16x16_bf16 v[100:103], v[68:69], v[70:71], v[100:103]
    v_cvt_pk_bf16_f32 v166, v64, v65
    v_cvt_pk_bf16_f32 v167, v66, v67
    v_mfma_f32_16x16x16_bf16 v[52:55], v[208:209], v[70:71], v[52:55]
    ds_write_b128 v245, v[164:167] offset:44032
    v_mfma_f32_16x16x32_bf16 v[28:31], v[210:213], v[120:123], 0
    v_cvt_pk_bf16_f32 v136, v136, v137
    v_cvt_pk_bf16_f32 v137, v138, v139
    v_mfma_f32_16x16x32_bf16 v[8:11], v[210:213], v[76:79], 0
    v_lshlrev_b32 v64, 16, v4
    v_and_b32 v65, 0xffff0000, v4
    v_mfma_f32_16x16x32_bf16 v[164:167], v[210:213], v[140:143], 0
    ds_write_b64 v246, v[136:137] offset:44032
    v_mfma_f32_16x16x32_bf16 v[76:79], v[210:213], v[204:207], 0
    v_lshlrev_b32 v66, 16, v5
    v_and_b32 v67, 0xffff0000, v5
    v_mfma_f32_16x16x16_bf16 v[28:31], v[214:215], v[36:37], v[28:31]
    v_lshlrev_b32 v132, 16, v6
    v_and_b32 v133, 0xffff0000, v6
    v_mfma_f32_16x16x16_bf16 v[8:11], v[214:215], v[38:39], v[8:11]
    v_lshlrev_b32 v134, 16, v7
    v_and_b32 v135, 0xffff0000, v7
    v_mfma_f32_16x16x16_bf16 v[164:167], v[214:215], v[68:69], v[164:167]
    v_lshlrev_b32 v128, 16, v20
    v_and_b32 v129, 0xffff0000, v20
    v_mfma_f32_16x16x16_bf16 v[76:79], v[214:215], v[208:209], v[76:79]
    v_lshlrev_b32 v130, 16, v21
    v_and_b32 v131, 0xffff0000, v21
    s_waitcnt lgkmcnt(0)
    s_barrier
    ds_read_b128 v[36:39], v247 offset:44032
    ds_read_b128 v[4:7], v247 offset:45056
    ds_read_b128 v[68:71], v247 offset:46080
    ds_read_b128 v[20:23], v247 offset:47104
    ds_read_b128 v[92:95], v247 offset:48128
    v_mov_b32 v79, 0xff800000
    v_cndmask_b32 v78, v79, v78, vcc
    v_mfma_f32_16x16x32_bf16 v[88:91], v[210:213], v[204:207], 0
    s_nop 0
    v_mov_b32_dpp v78, v30 quad_perm:[0,1,2,3] row_mask:0x1 bank_mask:0xf
    s_nop 1
    v_mov_b32_dpp v78, v10 quad_perm:[0,1,2,3] row_mask:0x2 bank_mask:0xf
    s_nop 0
    v_mfma_f32_16x16x16_bf16 v[88:91], v[214:215], v[208:209], v[88:91]
    v_mov_b32_dpp v78, v166 quad_perm:[0,1,2,3] row_mask:0x4 bank_mask:0xf
    s_waitcnt lgkmcnt(4)
    v_mfma_f32_16x16x32_bf16 v[80:83], a[216:219], v[36:39], v[80:83]
    ds_read_b128 v[28:31], v247 offset:49152
    s_waitcnt lgkmcnt(4)
    v_mfma_f32_16x16x32_bf16 v[80:83], a[228:231], v[4:7], v[80:83]
    s_waitcnt lgkmcnt(3)
    v_mul_f32 v78, s44, v78
    v_mfma_f32_16x16x32_bf16 v[80:83], a[240:243], v[68:71], v[80:83]
    s_waitcnt lgkmcnt(2)
    v_max_f32_dpp v79, v78, v78 row_ror:8 row_mask:0xf bank_mask:0xf
    v_mfma_f32_16x16x32_bf16 v[80:83], a[252:255], v[20:23], v[80:83]
    s_waitcnt lgkmcnt(1)
    v_max_f32_dpp v79, v79, v79 row_ror:4 row_mask:0xf bank_mask:0xf
    v_mfma_f32_16x16x32_bf16 v[80:83], v[180:183], v[92:95], v[80:83]
    v_lshlrev_b32 v8, 16, v108
    v_max_f32_dpp v79, v79, v79 row_ror:2 row_mask:0xf bank_mask:0xf
    v_mfma_f32_16x16x32_bf16 v[16:19], a[220:223], v[36:39], v[16:19]
    v_and_b32 v9, 0xffff0000, v108
    v_max_f32_dpp v79, v79, v79 row_ror:1 row_mask:0xf bank_mask:0xf
    v_mfma_f32_16x16x32_bf16 v[16:19], a[232:235], v[4:7], v[16:19]
    v_lshlrev_b32 v10, 16, v109
    v_max_f32_dpp v79, v79, v79 row_bcast:15 row_mask:0xa bank_mask:0xf
    v_mfma_f32_16x16x32_bf16 v[16:19], a[244:247], v[68:71], v[16:19]
    s_waitcnt lgkmcnt(0)
    ds_read_b128 v[164:167], v247 offset:25600
    v_max_f32_dpp v79, v79, v79 row_bcast:31 row_mask:0xc bank_mask:0xf
    v_mfma_f32_16x16x32_bf16 v[16:19], v[172:175], v[20:23], v[16:19]
    ds_read_b128 v[148:151], v247 offset:26624
    v_readlane_b32 s85, v79, 63
    v_mfma_f32_16x16x32_bf16 v[16:19], v[184:187], v[92:95], v[16:19]
    v_and_b32 v11, 0xffff0000, v109
    v_subrev_f32 v78, s85, v78
    v_mfma_f32_16x16x32_bf16 v[16:19], v[196:199], v[28:31], v[16:19]
    v_exp_f32 v78, v78
    v_mfma_f32_16x16x32_bf16 v[168:171], a[224:227], v[36:39], v[168:171]
    v_lshlrev_b32 v144, 16, v110
    v_add_f32_dpp v79, v78, v78 row_ror:8 row_mask:0xf bank_mask:0xf
    v_mfma_f32_16x16x32_bf16 v[168:171], a[236:239], v[4:7], v[168:171]
    v_and_b32 v145, 0xffff0000, v110
    v_add_f32_dpp v79, v79, v79 row_ror:4 row_mask:0xf bank_mask:0xf
    v_mfma_f32_16x16x32_bf16 v[168:171], a[248:251], v[68:71], v[168:171]
    ds_read_b128 v[36:39], v247 offset:27648
    v_cvt_pk_bf16_f32 v16, v16, v17
    v_mfma_f32_16x16x32_bf16 v[168:171], v[176:179], v[20:23], v[168:171]
    s_waitcnt lgkmcnt(2)
    ds_read_b128 v[4:7], v247 offset:28672
    v_cvt_pk_bf16_f32 v17, v18, v19
    v_mfma_f32_16x16x32_bf16 v[168:171], v[188:191], v[92:95], v[168:171]
    s_waitcnt lgkmcnt(2)
    v_add_f32_dpp v79, v79, v79 row_ror:2 row_mask:0xf bank_mask:0xf
    v_lshlrev_b32 v146, 16, v111
    v_mfma_f32_16x16x32_bf16 v[168:171], v[200:203], v[28:31], v[168:171]
    v_add_f32_dpp v79, v79, v79 row_ror:1 row_mask:0xf bank_mask:0xf
    v_and_b32 v147, 0xffff0000, v111
    v_mfma_f32_16x16x32_bf16 v[80:83], v[192:195], v[28:31], v[80:83]
    v_add_f32_dpp v79, v79, v79 row_bcast:15 row_mask:0xa bank_mask:0xf
    v_lshlrev_b32 v68, 16, v34
    v_mfma_f32_16x16x32_bf16 v[20:23], a[0:3], v[164:167], 0
    v_add_f32_dpp v79, v79, v79 row_bcast:31 row_mask:0xc bank_mask:0xf
    v_and_b32 v69, 0xffff0000, v34
    v_mfma_f32_16x16x32_bf16 v[20:23], a[12:15], v[148:151], v[20:23]
    ds_read_b128 v[92:95], v247 offset:29696
    s_waitcnt lgkmcnt(2)
    v_mfma_f32_16x16x32_bf16 v[20:23], a[24:27], v[36:39], v[20:23]
    ds_read_b128 v[108:111], v247 offset:30720
    s_waitcnt lgkmcnt(2)
    v_mfma_f32_16x16x32_bf16 v[20:23], a[36:39], v[4:7], v[20:23]
    v_cvt_pk_bf16_f32 v80, v80, v81
    v_cvt_pk_bf16_f32 v81, v82, v83
    v_mfma_f32_16x16x32_bf16 v[28:31], a[4:7], v[164:167], 0
    ds_write_b64 v242, v[80:81] offset:0
    v_mfma_f32_16x16x32_bf16 v[28:31], a[16:19], v[148:151], v[28:31]
    v_cvt_pk_bf16_f32 v168, v168, v169
    v_cvt_pk_bf16_f32 v169, v170, v171
    v_mfma_f32_16x16x32_bf16 v[28:31], a[28:31], v[36:39], v[28:31]
    ds_write_b64 v242, v[16:17] offset:32
    v_mfma_f32_16x16x32_bf16 v[28:31], a[40:43], v[4:7], v[28:31]
    s_waitcnt lgkmcnt(3)
    v_readlane_b32 s85, v79, 63
    v_lshlrev_b32 v70, 16, v35
    v_mfma_f32_16x16x32_bf16 v[28:31], a[52:55], v[92:95], v[28:31]
    s_waitcnt lgkmcnt(2)
    ds_read_b128 v[80:83], v247 offset:31744
    ds_read_b128 v[16:19], v247 offset:32768
    v_mfma_f32_16x16x32_bf16 v[28:31], a[64:67], v[108:111], v[28:31]
    ds_write_b64 v242, v[168:169] offset:64
    v_mfma_f32_16x16x32_bf16 v[168:171], a[8:11], v[164:167], 0
    v_rcp_f32 v79, s85
    v_mfma_f32_16x16x32_bf16 v[168:171], a[20:23], v[148:151], v[168:171]
    v_mul_f32 v78, v78, v79
    v_cvt_pk_bf16_f32 v78, v78, v78
    v_mfma_f32_16x16x32_bf16 v[168:171], a[32:35], v[36:39], v[168:171]
    ds_write_b16 v104, v78 offset:0
    v_mfma_f32_16x16x32_bf16 v[168:171], a[44:47], v[4:7], v[168:171]
    ds_read_b128 v[164:167], v247 offset:33792
    v_and_b32 v71, 0xffff0000, v35
    v_mfma_f32_16x16x32_bf16 v[168:171], a[56:59], v[92:95], v[168:171]
    ds_read_b128 v[148:151], v247 offset:34816
    v_max3_f32 v52, v112, v113, v54
    v_mfma_f32_16x16x32_bf16 v[168:171], a[68:71], v[108:111], v[168:171]
    s_waitcnt lgkmcnt(5)
    v_max3_f32 v53, v114, v115, v72
    v_max3_f32 v52, v52, v73, v74
    v_mfma_f32_16x16x32_bf16 v[20:23], a[48:51], v[92:95], v[20:23]
    s_waitcnt lgkmcnt(4)
    v_max3_f32 v53, v53, v75, v100
    v_max3_f32 v52, v52, v101, v102
    v_mfma_f32_16x16x32_bf16 v[20:23], a[60:63], v[108:111], v[20:23]
    v_max3_f32 v52, v52, v53, v103
    v_cvt_pk_bf16_f32 v168, v168, v169
    v_mfma_f32_16x16x32_bf16 v[76:79], a[0:3], v[80:83], 0
    v_cvt_pk_bf16_f32 v169, v170, v171
    v_mov_b32 v53, v52
    v_mfma_f32_16x16x32_bf16 v[76:79], a[12:15], v[16:19], v[76:79]
    ds_read_b128 v[4:7], v247 offset:35840
    s_waitcnt lgkmcnt(2)
    v_mfma_f32_16x16x32_bf16 v[76:79], a[24:27], v[164:167], v[76:79]
    ds_read_b128 v[92:95], v247 offset:36864
    s_waitcnt lgkmcnt(2)
    v_mfma_f32_16x16x32_bf16 v[76:79], a[36:39], v[148:151], v[76:79]
    v_cvt_pk_bf16_f32 v20, v20, v21
    v_cvt_pk_bf16_f32 v21, v22, v23
    v_mfma_f32_16x16x32_bf16 v[108:111], a[4:7], v[80:83], 0
    v_cvt_pk_bf16_f32 v22, v28, v29
    v_cvt_pk_bf16_f32 v23, v30, v31
    v_mfma_f32_16x16x32_bf16 v[108:111], a[16:19], v[16:19], v[108:111]
    v_permlane32_swap_b32 v52, v53
    v_mfma_f32_16x16x32_bf16 v[108:111], a[28:31], v[164:167], v[108:111]
    v_max_f32 v52, v52, v53
    v_mov_b32 v53, v52
    v_mfma_f32_16x16x32_bf16 v[108:111], a[40:43], v[148:151], v[108:111]
    s_waitcnt lgkmcnt(1)
    v_permlane16_swap_b32 v52, v53
    v_mfma_f32_16x16x32_bf16 v[108:111], a[52:55], v[4:7], v[108:111]
    s_waitcnt lgkmcnt(0)
    v_max_f32 v52, v52, v53
    v_mfma_f32_16x16x32_bf16 v[108:111], a[64:67], v[92:95], v[108:111]
    ds_read_b128 v[28:31], v247 offset:50176
    v_mul_f32 v52, s44, v52
    v_mfma_f32_16x16x32_bf16 v[44:47], a[8:11], v[80:83], 0
    ds_read_b128 v[40:43], v247 offset:51200
    v_fma_f32 v112, v112, s44, -v52
    v_mfma_f32_16x16x32_bf16 v[44:47], a[20:23], v[16:19], v[44:47]
    ds_read_b128 v[80:83], v247 offset:52224
    v_fma_f32 v113, v113, s44, -v52
    v_mfma_f32_16x16x32_bf16 v[44:47], a[32:35], v[164:167], v[44:47]
    v_fma_f32 v114, v114, s44, -v52
    v_fma_f32 v115, v115, s44, -v52
    v_mfma_f32_16x16x32_bf16 v[44:47], a[44:47], v[148:151], v[44:47]
    v_fma_f32 v72, v72, s44, -v52
    v_fma_f32 v73, v73, s44, -v52
    v_mfma_f32_16x16x32_bf16 v[44:47], a[56:59], v[4:7], v[44:47]
    v_fma_f32 v74, v74, s44, -v52
    v_fma_f32 v75, v75, s44, -v52
    v_mfma_f32_16x16x32_bf16 v[44:47], a[68:71], v[92:95], v[44:47]
    v_fma_f32 v100, v100, s44, -v52
    v_fma_f32 v101, v101, s44, -v52
    v_mfma_f32_16x16x32_bf16 v[76:79], a[48:51], v[4:7], v[76:79]
    s_waitcnt lgkmcnt(2)
    v_fma_f32 v102, v102, s44, -v52
    v_fma_f32 v103, v103, s44, -v52
    v_mfma_f32_16x16x32_bf16 v[76:79], a[60:63], v[92:95], v[76:79]
    s_waitcnt lgkmcnt(1)
    v_fma_f32 v54, v54, s44, -v52
    v_cvt_pk_bf16_f32 v170, v44, v45
    v_mfma_f32_16x16x32_bf16 v[16:19], v[210:213], v[20:23], 0
    s_waitcnt lgkmcnt(0)
    ds_read_b128 v[164:167], v247 offset:53248
    v_cvt_pk_bf16_f32 v171, v46, v47
    v_mfma_f32_16x16x32_bf16 v[8:11], a[216:219], v[28:31], v[8:11]
    ds_read_b128 v[148:151], v247 offset:54272
    v_cvt_pk_bf16_f32 v76, v76, v77
    v_mfma_f32_16x16x32_bf16 v[8:11], a[228:231], v[40:43], v[8:11]
    ds_read_b128 v[4:7], v105 offset:0
    v_cvt_pk_bf16_f32 v77, v78, v79
    v_mfma_f32_16x16x32_bf16 v[8:11], a[240:243], v[80:83], v[8:11]
    v_cvt_pk_bf16_f32 v78, v108, v109
    v_cvt_pk_bf16_f32 v79, v110, v111
    v_mfma_f32_16x16x16_bf16 v[16:19], v[214:215], v[168:169], v[16:19]
    v_exp_f32 v112, v112
    v_mfma_f32_16x16x32_bf16 v[92:95], v[210:213], v[76:79], 0
    v_exp_f32 v113, v113
    v_mfma_f32_16x16x32_bf16 v[144:147], a[220:223], v[28:31], v[144:147]
    ds_read_b128 v[44:47], v247 offset:55296
    v_exp_f32 v114, v114
    v_mfma_f32_16x16x32_bf16 v[144:147], a[232:235], v[40:43], v[144:147]
    s_waitcnt lgkmcnt(3)
    v_exp_f32 v115, v115
    v_mfma_f32_16x16x32_bf16 v[144:147], a[244:247], v[80:83], v[144:147]
    s_waitcnt lgkmcnt(2)
    v_exp_f32 v72, v72
    v_mfma_f32_16x16x32_bf16 v[144:147], v[172:175], v[164:167], v[144:147]
    s_waitcnt lgkmcnt(1)
    ds_read_b128 v[108:111], v105 offset:64
    v_exp_f32 v73, v73
    v_mfma_f32_16x16x32_bf16 v[144:147], v[184:187], v[148:151], v[144:147]
    v_exp_f32 v74, v74
    v_mfma_f32_16x16x16_bf16 v[92:95], v[214:215], v[170:171], v[92:95]
    v_exp_f32 v75, v75
    v_mfma_f32_16x16x32_bf16 v[68:71], a[224:227], v[28:31], v[68:71]
    v_exp_f32 v100, v100
    v_mfma_f32_16x16x32_bf16 v[68:71], a[236:239], v[40:43], v[68:71]
    s_waitcnt lgkmcnt(1)
    v_exp_f32 v101, v101
    v_mfma_f32_16x16x32_bf16 v[68:71], a[248:251], v[80:83], v[68:71]
    v_exp_f32 v102, v102
    v_mfma_f32_16x16x32_bf16 v[68:71], v[176:179], v[164:167], v[68:71]
    v_exp_f32 v103, v103
    v_mfma_f32_16x16x32_bf16 v[68:71], v[188:191], v[148:151], v[68:71]
    s_waitcnt lgkmcnt(0)
    v_exp_f32 v54, v54
    v_mfma_f32_16x16x32_bf16 v[68:71], v[200:203], v[44:47], v[68:71]
    ds_read_b128 v[28:31], v247 offset:37888
    v_cvt_pk_bf16_f32 v112, v112, v113
    v_mfma_f32_16x16x32_bf16 v[8:11], a[252:255], v[164:167], v[8:11]
    ds_read_b128 v[40:43], v247 offset:38912
    v_cvt_pk_bf16_f32 v113, v114, v115
    v_mfma_f32_16x16x32_bf16 v[8:11], v[180:183], v[148:151], v[8:11]
    v_cvt_pk_bf16_f32 v114, v72, v73
    v_cvt_pk_bf16_f32 v115, v74, v75
    v_mfma_f32_16x16x32_bf16 v[8:11], v[192:195], v[44:47], v[8:11]
    v_cvt_pk_bf16_f32 v68, v68, v69
    v_cvt_pk_bf16_f32 v69, v70, v71
    v_mfma_f32_16x16x32_bf16 v[80:83], v[228:231], v[112:115], 0
    v_cvt_pk_bf16_f32 v100, v100, v101
    v_cvt_pk_bf16_f32 v101, v102, v103
    v_mfma_f32_16x16x32_bf16 v[164:167], v[160:163], v[112:115], 0
    v_cvt_pk_bf16_f32 v103, v54, 0
    v_mov_b32 v102, 0
    v_mfma_f32_16x16x32_bf16 v[148:151], v[24:27], v[112:115], 0
    v_cvt_pk_bf16_f32 v8, v8, v9
    v_cvt_pk_bf16_f32 v9, v10, v11
    v_mfma_f32_16x16x32_bf16 v[148:151], v[220:223], v[100:103], v[148:151]
    s_waitcnt lgkmcnt(1)
    ds_write_b64 v243, v[8:9] offset:0
    v_mfma_f32_16x16x32_bf16 v[72:75], v[48:51], v[112:115], 0
    s_waitcnt lgkmcnt(1)
    v_mfma_f32_16x16x32_bf16 v[72:75], v[224:227], v[100:103], v[72:75]
    v_mfma_f32_16x16x32_bf16 v[80:83], v[230:233], v[100:103], v[80:83]
    v_mfma_f32_16x16x32_bf16 v[164:167], v[216:219], v[100:103], v[164:167]
    v_mfma_f32_16x16x32_bf16 v[52:55], v[160:163], v[4:7], 0
    v_mfma_f32_16x16x32_bf16 v[52:55], v[216:219], v[108:111], v[52:55]
    v_mfma_f32_16x16x32_bf16 v[8:11], v[24:27], v[4:7], 0
    ds_read_b128 v[112:115], v247 offset:39936
    v_mfma_f32_16x16x32_bf16 v[8:11], v[220:223], v[108:111], v[8:11]
    ds_read_b128 v[100:103], v247 offset:40960
    v_mfma_f32_16x16x32_bf16 v[160:163], v[48:51], v[4:7], 0
    v_rcp_f32 v80, v80
    v_mfma_f32_16x16x32_bf16 v[160:163], v[224:227], v[108:111], v[160:163]
    v_mul_f32 v164, v164, v80
    v_mul_f32 v165, v165, v80
    v_mfma_f32_16x16x32_bf16 v[144:147], v[196:199], v[44:47], v[144:147]
    v_mul_f32 v166, v166, v80
    v_mul_f32 v167, v167, v80
    v_mfma_f32_16x16x32_bf16 v[24:27], a[0:3], v[28:31], 0
    v_mul_f32 v148, v148, v80
    v_mul_f32 v149, v149, v80
    v_mfma_f32_16x16x32_bf16 v[24:27], a[12:15], v[40:43], v[24:27]
    ds_read_b128 v[4:7], v247 offset:41984
    s_waitcnt lgkmcnt(2)
    v_mfma_f32_16x16x32_bf16 v[24:27], a[24:27], v[112:115], v[24:27]
    ds_read_b128 v[48:51], v247 offset:43008
    s_waitcnt lgkmcnt(2)
    v_mfma_f32_16x16x32_bf16 v[24:27], a[36:39], v[100:103], v[24:27]
    v_mul_f32 v150, v150, v80
    v_mul_f32 v151, v151, v80
    v_mfma_f32_16x16x32_bf16 v[108:111], a[4:7], v[28:31], 0
    v_mul_f32 v72, v72, v80
    v_mul_f32 v73, v73, v80
    v_mfma_f32_16x16x32_bf16 v[108:111], a[16:19], v[40:43], v[108:111]
    v_mul_f32 v74, v74, v80
    v_mul_f32 v75, v75, v80
    v_mfma_f32_16x16x32_bf16 v[108:111], a[28:31], v[112:115], v[108:111]
    v_cvt_pk_bf16_f32 v164, v164, v165
    v_cvt_pk_bf16_f32 v165, v166, v167
    v_mfma_f32_16x16x32_bf16 v[108:111], a[40:43], v[100:103], v[108:111]
    ds_read_b128 v[44:47], v247 offset:25600
    s_waitcnt lgkmcnt(2)
    v_mfma_f32_16x16x32_bf16 v[108:111], a[52:55], v[4:7], v[108:111]
    ds_read_b128 v[80:83], v247 offset:26624
    s_waitcnt lgkmcnt(2)
    v_mfma_f32_16x16x32_bf16 v[108:111], a[64:67], v[48:51], v[108:111]
    ds_read_b128 v[60:63], v247 offset:27648
    v_cvt_pk_bf16_f32 v166, v148, v149
    v_mfma_f32_16x16x32_bf16 v[56:59], a[8:11], v[28:31], 0
    ds_read_b128 v[28:31], v247 offset:28672
    v_cvt_pk_bf16_f32 v167, v150, v151
    v_mfma_f32_16x16x32_bf16 v[56:59], a[20:23], v[40:43], v[56:59]
    ds_read_b128 v[148:151], v247 offset:29696
    v_cvt_pk_bf16_f32 v72, v72, v73
    v_mfma_f32_16x16x32_bf16 v[56:59], a[32:35], v[112:115], v[56:59]
    ds_read_b128 v[40:43], v247 offset:30720
    v_cvt_pk_bf16_f32 v73, v74, v75
    v_mfma_f32_16x16x32_bf16 v[56:59], a[44:47], v[100:103], v[56:59]
    ds_write_b128 v245, v[164:167] offset:56320
    v_mfma_f32_16x16x32_bf16 v[56:59], a[56:59], v[4:7], v[56:59]
    s_waitcnt lgkmcnt(5)
    v_cvt_pk_bf16_f32 v52, v52, v53
    v_cvt_pk_bf16_f32 v53, v54, v55
    v_mfma_f32_16x16x32_bf16 v[56:59], a[68:71], v[48:51], v[56:59]
    s_waitcnt lgkmcnt(4)
    v_cvt_pk_bf16_f32 v54, v8, v9
    v_cvt_pk_bf16_f32 v55, v10, v11
    v_mfma_f32_16x16x32_bf16 v[24:27], a[48:51], v[4:7], v[24:27]
    s_waitcnt lgkmcnt(3)
    ds_write_b64 v246, v[72:73] offset:56320
    v_mfma_f32_16x16x32_bf16 v[24:27], a[60:63], v[48:51], v[24:27]
    s_waitcnt lgkmcnt(3)
    v_cvt_pk_bf16_f32 v160, v160, v161
    v_cvt_pk_bf16_f32 v161, v162, v163
    v_mfma_f32_16x16x32_bf16 v[112:115], a[144:147], v[44:47], 0
    s_waitcnt lgkmcnt(2)
    v_cvt_pk_bf16_f32 v144, v144, v145
    v_cvt_pk_bf16_f32 v145, v146, v147
    v_mfma_f32_16x16x32_bf16 v[112:115], a[156:159], v[80:83], v[112:115]
    ds_write_b64 v243, v[144:145] offset:32
    v_mfma_f32_16x16x32_bf16 v[112:115], a[168:171], v[60:63], v[112:115]
    v_cvt_pk_bf16_f32 v24, v24, v25
    v_cvt_pk_bf16_f32 v25, v26, v27
    v_mfma_f32_16x16x32_bf16 v[112:115], a[180:183], v[28:31], v[112:115]
    ds_write_b64 v243, v[68:69] offset:64
    v_mfma_f32_16x16x32_bf16 v[112:115], a[192:195], v[148:151], v[112:115]
    s_mov_b32 vcc_lo, 0
    v_cvt_pk_bf16_f32 v26, v108, v109
    v_cvt_pk_bf16_f32 v27, v110, v111
    v_mfma_f32_16x16x32_bf16 v[112:115], a[204:207], v[40:43], v[112:115]
    s_mov_b32 vcc_hi, 0x80000
    v_cvt_pk_bf16_f32 v56, v56, v57
    v_cvt_pk_bf16_f32 v57, v58, v59
    v_mfma_f32_16x16x32_bf16 v[100:103], v[210:213], v[24:27], 0
    v_mov_b32 v88, 0xff800000
    v_cndmask_b32 v91, v88, v91, vcc
    v_mfma_f32_16x16x32_bf16 v[164:167], a[148:151], v[44:47], 0
    v_mfma_f32_16x16x32_bf16 v[164:167], a[160:163], v[80:83], v[164:167]
    v_cvt_pk_bf16_f32 v112, v112, v113
    v_cvt_pk_bf16_f32 v113, v114, v115
    v_mfma_f32_16x16x32_bf16 v[164:167], a[172:175], v[60:63], v[164:167]
    s_waitcnt lgkmcnt(0)
    s_barrier
    v_mfma_f32_16x16x32_bf16 v[164:167], a[184:187], v[28:31], v[164:167]
    v_mov_b32_dpp v91, v19 quad_perm:[0,1,2,3] row_mask:0x1 bank_mask:0xf
    v_mfma_f32_16x16x32_bf16 v[164:167], a[196:199], v[148:151], v[164:167]
    ds_read_b128 v[8:11], v247 offset:56320
    ds_read_b128 v[4:7], v247 offset:57344
    v_mfma_f32_16x16x32_bf16 v[164:167], a[208:211], v[40:43], v[164:167]
    ds_read_b128 v[72:75], v247 offset:58368
    ds_read_b128 v[48:51], v247 offset:59392
    v_mfma_f32_16x16x16_bf16 v[100:103], v[214:215], v[56:57], v[100:103]
    ds_read_b128 v[144:147], v247 offset:60416
    ds_read_b128 v[68:71], v253 offset:0
    v_mfma_f32_16x16x32_bf16 v[108:111], a[152:155], v[44:47], 0
    s_mov_b64 exec, s[64:65]
    ds_write_b128 v250, v[52:55] offset:1536
    ds_write_b64 v251, v[160:161] offset:1536
    s_mov_b64 exec, -1
    v_mfma_f32_16x16x32_bf16 v[108:111], a[164:167], v[80:83], v[108:111]
    s_waitcnt lgkmcnt(6)
    v_cvt_pk_bf16_f32 v114, v164, v165
    v_cvt_pk_bf16_f32 v115, v166, v167
    v_mfma_f32_16x16x32_bf16 v[108:111], a[176:179], v[60:63], v[108:111]
    s_waitcnt lgkmcnt(5)
    ds_read_b128 v[16:19], v253 offset:2800
    ds_read_b128 v[52:55], v253 offset:5600
    v_mfma_f32_16x16x32_bf16 v[108:111], a[188:191], v[28:31], v[108:111]
    s_waitcnt lgkmcnt(6)
    ds_read_b128 v[152:155], v253 offset:8400
    v_mov_b32_dpp v91, v95 quad_perm:[0,1,2,3] row_mask:0x2 bank_mask:0xf
    v_mfma_f32_16x16x32_bf16 v[108:111], a[200:203], v[148:151], v[108:111]
    s_waitcnt lgkmcnt(6)
    s_waitcnt lgkmcnt(5)
    buffer_store_dwordx4 v[68:71], v254, s[32:35], s71 offen nt
    v_mfma_f32_16x16x32_bf16 v[108:111], a[212:215], v[40:43], v[108:111]
    s_add_u32 s71, s39, 1548288
    v_mov_b32_dpp v91, v103 quad_perm:[0,1,2,3] row_mask:0x4 bank_mask:0xf
    v_mfma_f32_16x16x32_bf16 v[64:67], a[216:219], v[8:11], v[64:67]
    ds_read_b128 v[156:159], v247 offset:61440
    v_mfma_f32_16x16x32_bf16 v[64:67], a[228:231], v[4:7], v[64:67]
    v_mfma_f32_16x16x32_bf16 v[64:67], a[240:243], v[72:75], v[64:67]
    s_waitcnt lgkmcnt(3)
    v_mfma_f32_16x16x32_bf16 v[64:67], a[252:255], v[48:51], v[64:67]
    s_waitcnt lgkmcnt(2)
    v_cvt_pk_bf16_f32 v58, v108, v109
    v_cvt_pk_bf16_f32 v59, v110, v111
    v_mfma_f32_16x16x32_bf16 v[64:67], v[180:183], v[144:147], v[64:67]
    s_waitcnt lgkmcnt(1)
    v_mfma_f32_16x16x32_bf16 v[132:135], a[220:223], v[8:11], v[132:135]
    buffer_store_dwordx4 v[16:19], v254, s[32:35], s68 offen nt
    v_mfma_f32_16x16x32_bf16 v[132:135], a[232:235], v[4:7], v[132:135]
    s_waitcnt lgkmcnt(0)
    s_add_u32 s68, s39, 1634304
    v_mfma_f32_16x16x32_bf16 v[132:135], a[244:247], v[72:75], v[132:135]
    v_mfma_f32_16x16x32_bf16 v[132:135], v[172:175], v[48:51], v[132:135]
    v_mfma_f32_16x16x32_bf16 v[132:135], v[184:187], v[144:147], v[132:135]
    v_mfma_f32_16x16x32_bf16 v[132:135], v[196:199], v[156:159], v[132:135]
    v_mfma_f32_16x16x32_bf16 v[128:131], a[224:227], v[8:11], v[128:131]
    v_mfma_f32_16x16x32_bf16 v[128:131], a[236:239], v[4:7], v[128:131]
    buffer_store_dwordx4 v[52:55], v254, s[32:35], s69 offen nt
    v_mfma_f32_16x16x32_bf16 v[128:131], a[248:251], v[72:75], v[128:131]
    s_add_u32 s69, s39, 1720320
    v_mfma_f32_16x16x32_bf16 v[128:131], v[176:179], v[48:51], v[128:131]
    v_mfma_f32_16x16x32_bf16 v[128:131], v[188:191], v[144:147], v[128:131]
    v_mfma_f32_16x16x32_bf16 v[128:131], v[200:203], v[156:159], v[128:131]
    v_cvt_pk_bf16_f32 v132, v132, v133
    v_cvt_pk_bf16_f32 v133, v134, v135
    v_mfma_f32_16x16x32_bf16 v[64:67], v[192:195], v[156:159], v[64:67]
    v_mfma_f32_16x16x32_bf16 v[92:95], v[20:23], v[112:115], 0
    v_mfma_f32_16x16x32_bf16 v[68:71], v[76:79], v[112:115], 0
    buffer_store_dwordx4 v[152:155], v254, s[32:35], s70 offen nt
    v_mfma_f32_16x16x32_bf16 v[100:103], v[24:27], v[112:115], 0
    v_mfma_f32_16x16x32_bf16 v[108:111], v[204:207], v[112:115], 0
    v_cvt_pk_bf16_f32 v128, v128, v129
    v_cvt_pk_bf16_f32 v129, v130, v131
    v_mfma_f32_16x16x16_bf16 v[92:95], v[168:169], v[58:59], v[92:95]
    v_cvt_pk_bf16_f32 v64, v64, v65
    v_cvt_pk_bf16_f32 v65, v66, v67
    v_mfma_f32_16x16x16_bf16 v[68:71], v[170:171], v[58:59], v[68:71]
    ds_write_b64 v244, v[64:65] offset:0
    v_mfma_f32_16x16x16_bf16 v[100:103], v[56:57], v[58:59], v[100:103]
    v_mul_f32 v91, s44, v91
    v_mfma_f32_16x16x16_bf16 v[108:111], v[208:209], v[58:59], v[108:111]
    ds_write_b64 v244, v[132:133] offset:32
    v_mfma_f32_16x16x32_bf16 v[16:19], v[44:47], a[72:75], 0
    v_max_f32_dpp v88, v91, v91 row_ror:8 row_mask:0xf bank_mask:0xf
    v_mfma_f32_16x16x32_bf16 v[16:19], v[80:83], a[84:87], v[16:19]
    ds_write_b64 v244, v[128:129] offset:64
    v_mfma_f32_16x16x32_bf16 v[16:19], v[60:63], a[96:99], v[16:19]
    v_max_f32_dpp v88, v88, v88 row_ror:4 row_mask:0xf bank_mask:0xf
    v_mfma_f32_16x16x32_bf16 v[16:19], v[28:31], a[108:111], v[16:19]
    v_max3_f32 v108, v92, v93, v111
    v_max3_f32 v109, v94, v95, v68
    v_mfma_f32_16x16x32_bf16 v[16:19], v[148:151], a[120:123], v[16:19]
    v_max3_f32 v108, v108, v69, v70
    v_max3_f32 v109, v109, v71, v100
    v_mfma_f32_16x16x32_bf16 v[16:19], v[40:43], a[132:135], v[16:19]
    v_max3_f32 v108, v108, v101, v102
    v_max3_f32 v108, v108, v109, v103
    v_mfma_f32_16x16x32_bf16 v[8:11], v[44:47], a[76:79], 0
    v_mov_b32 v109, v108
    v_max_f32_dpp v88, v88, v88 row_ror:2 row_mask:0xf bank_mask:0xf
    v_mfma_f32_16x16x32_bf16 v[8:11], v[80:83], a[88:91], v[8:11]
    ds_read_b128 v[4:7], v247 offset:31744
    s_waitcnt lgkmcnt(1)
    s_barrier
    v_mfma_f32_16x16x32_bf16 v[8:11], v[60:63], a[100:103], v[8:11]
    ds_read_b128 v[72:75], v247 offset:32768
    v_cvt_pk_bf16_f32 v16, v16, v17
    v_mfma_f32_16x16x32_bf16 v[8:11], v[28:31], a[112:115], v[8:11]
    ds_read_b128 v[144:147], v247 offset:33792
    ds_read_b128 v[112:115], v253 offset:16800
    v_mfma_f32_16x16x32_bf16 v[8:11], v[148:151], a[124:127], v[8:11]
    ds_read_b128 v[64:67], v247 offset:34816
    ds_read_b128 v[124:127], v253 offset:11200
    v_mfma_f32_16x16x32_bf16 v[8:11], v[40:43], a[136:139], v[8:11]
    ds_read_b128 v[120:123], v247 offset:35840
    ds_read_b128 v[140:143], v253 offset:14000
    v_mfma_f32_16x16x32_bf16 v[136:139], v[44:47], a[80:83], 0
    ds_read_b128 v[44:47], v247 offset:36864
    v_cvt_pk_bf16_f32 v17, v18, v19
    v_mfma_f32_16x16x32_bf16 v[136:139], v[80:83], a[92:95], v[136:139]
    v_permlane32_swap_b32 v108, v109
    v_mfma_f32_16x16x32_bf16 v[136:139], v[60:63], a[104:107], v[136:139]
    s_waitcnt lgkmcnt(8)
    v_cvt_pk_bf16_f32 v8, v8, v9
    v_cvt_pk_bf16_f32 v9, v10, v11
    v_mfma_f32_16x16x32_bf16 v[136:139], v[28:31], a[116:119], v[136:139]
    s_waitcnt lgkmcnt(7)
    v_max_f32 v108, v108, v109
    v_mov_b32 v109, v108
    v_mfma_f32_16x16x32_bf16 v[136:139], v[148:151], a[128:131], v[136:139]
    s_waitcnt lgkmcnt(6)
    v_permlane16_swap_b32 v108, v109
    v_mfma_f32_16x16x32_bf16 v[136:139], v[40:43], a[140:143], v[136:139]
    s_waitcnt lgkmcnt(5)
    v_max_f32 v108, v108, v109
    v_mul_f32 v108, s44, v108
    v_mfma_f32_16x16x32_bf16 v[80:83], a[144:147], v[4:7], 0
    s_waitcnt lgkmcnt(4)
    s_waitcnt lgkmcnt(3)
    buffer_store_dwordx4 v[124:127], v254, s[32:35], s71 offen nt
    v_mfma_f32_16x16x32_bf16 v[80:83], a[156:159], v[72:75], v[80:83]
    s_waitcnt lgkmcnt(2)
    v_cvt_pk_bf16_f32 v136, v136, v137
    v_cvt_pk_bf16_f32 v137, v138, v139
    v_mfma_f32_16x16x32_bf16 v[80:83], a[168:171], v[144:147], v[80:83]
    s_waitcnt lgkmcnt(1)
    v_fma_f32 v92, v92, s44, -v108
    v_fma_f32 v93, v93, s44, -v108
    v_mfma_f32_16x16x32_bf16 v[80:83], a[180:183], v[64:67], v[80:83]
    s_waitcnt lgkmcnt(0)
    v_fma_f32 v94, v94, s44, -v108
    v_fma_f32 v95, v95, s44, -v108
    v_mfma_f32_16x16x32_bf16 v[80:83], a[192:195], v[120:123], v[80:83]
    v_fma_f32 v68, v68, s44, -v108
    v_fma_f32 v69, v69, s44, -v108
    v_mfma_f32_16x16x32_bf16 v[80:83], a[204:207], v[44:47], v[80:83]
    v_fma_f32 v70, v70, s44, -v108
    v_fma_f32 v71, v71, s44, -v108
    v_mfma_f32_16x16x32_bf16 v[60:63], a[148:151], v[4:7], 0
    v_fma_f32 v100, v100, s44, -v108
    v_fma_f32 v101, v101, s44, -v108
    v_mfma_f32_16x16x32_bf16 v[60:63], a[160:163], v[72:75], v[60:63]
    v_fma_f32 v102, v102, s44, -v108
    v_fma_f32 v103, v103, s44, -v108
    v_mfma_f32_16x16x32_bf16 v[60:63], a[172:175], v[144:147], v[60:63]
    buffer_store_dwordx4 v[140:143], v254, s[32:35], s68 offen nt
    v_mfma_f32_16x16x32_bf16 v[60:63], a[184:187], v[64:67], v[60:63]
    v_cvt_pk_bf16_f32 v80, v80, v81
    v_cvt_pk_bf16_f32 v81, v82, v83
    v_mfma_f32_16x16x32_bf16 v[60:63], a[196:199], v[120:123], v[60:63]
    v_fma_f32 v111, v111, s44, -v108
    v_exp_f32 v92, v92
    v_mfma_f32_16x16x32_bf16 v[60:63], a[208:211], v[44:47], v[60:63]
    v_exp_f32 v93, v93
    v_mfma_f32_16x16x32_bf16 v[28:31], a[152:155], v[4:7], 0
    v_exp_f32 v94, v94
    v_mfma_f32_16x16x32_bf16 v[28:31], a[164:167], v[72:75], v[28:31]
    v_exp_f32 v95, v95
    v_mfma_f32_16x16x32_bf16 v[28:31], a[176:179], v[144:147], v[28:31]
    v_exp_f32 v68, v68
    v_mfma_f32_16x16x32_bf16 v[28:31], a[188:191], v[64:67], v[28:31]
    s_mov_b64 exec, s[48:49]
    buffer_store_dwordx4 v[112:115], v254, s[32:35], s69 offen nt
    s_mov_b64 exec, -1
    v_mfma_f32_16x16x32_bf16 v[28:31], a[200:203], v[120:123], v[28:31]
    v_cvt_pk_bf16_f32 v82, v60, v61
    v_cvt_pk_bf16_f32 v83, v62, v63
    v_mfma_f32_16x16x32_bf16 v[28:31], a[212:215], v[44:47], v[28:31]
    v_exp_f32 v69, v69
    v_mfma_f32_16x16x32_bf16 v[148:151], v[4:7], a[72:75], 0
    v_exp_f32 v70, v70
    v_mfma_f32_16x16x32_bf16 v[148:151], v[72:75], a[84:87], v[148:151]
    v_exp_f32 v71, v71
    v_mfma_f32_16x16x32_bf16 v[148:151], v[144:147], a[96:99], v[148:151]
    v_exp_f32 v100, v100
    v_mfma_f32_16x16x32_bf16 v[148:151], v[64:67], a[108:111], v[148:151]
    v_cvt_pk_bf16_f32 v58, v28, v29
    v_cvt_pk_bf16_f32 v59, v30, v31
    v_mfma_f32_16x16x32_bf16 v[148:151], v[120:123], a[120:123], v[148:151]
    v_exp_f32 v101, v101
    v_mfma_f32_16x16x32_bf16 v[148:151], v[44:47], a[132:135], v[148:151]
    v_exp_f32 v102, v102
    v_mfma_f32_16x16x32_bf16 v[40:43], v[4:7], a[76:79], 0
    v_exp_f32 v103, v103
    v_mfma_f32_16x16x32_bf16 v[40:43], v[72:75], a[88:91], v[40:43]
    v_exp_f32 v111, v111
    v_mfma_f32_16x16x32_bf16 v[40:43], v[144:147], a[100:103], v[40:43]
    v_cvt_pk_bf16_f32 v92, v92, v93
    v_cvt_pk_bf16_f32 v93, v94, v95
    v_mfma_f32_16x16x32_bf16 v[40:43], v[64:67], a[112:115], v[40:43]
    v_cvt_pk_bf16_f32 v18, v148, v149
    v_cvt_pk_bf16_f32 v19, v150, v151
    v_mfma_f32_16x16x32_bf16 v[40:43], v[120:123], a[124:127], v[40:43]
    v_cvt_pk_bf16_f32 v94, v68, v69
    v_cvt_pk_bf16_f32 v95, v70, v71
    v_mfma_f32_16x16x32_bf16 v[40:43], v[44:47], a[136:139], v[40:43]
    v_cvt_pk_bf16_f32 v100, v100, v101
    v_cvt_pk_bf16_f32 v101, v102, v103
    v_mfma_f32_16x16x32_bf16 v[124:127], v[4:7], a[80:83], 0
    v_cvt_pk_bf16_f32 v103, 0, v111
    v_mov_b32 v102, 0
    v_mfma_f32_16x16x32_bf16 v[124:127], v[72:75], a[92:95], v[124:127]
    v_max_f32_dpp v88, v88, v88 row_ror:1 row_mask:0xf bank_mask:0xf
    v_mfma_f32_16x16x32_bf16 v[124:127], v[144:147], a[104:107], v[124:127]
    v_cvt_pk_bf16_f32 v10, v40, v41
    v_cvt_pk_bf16_f32 v11, v42, v43
    v_mfma_f32_16x16x32_bf16 v[124:127], v[64:67], a[116:119], v[124:127]
    ds_read_b128 v[140:143], v247 offset:37888
    v_max_f32_dpp v88, v88, v88 row_bcast:15 row_mask:0xa bank_mask:0xf
    v_mfma_f32_16x16x32_bf16 v[124:127], v[120:123], a[128:131], v[124:127]
    ds_read_b128 v[112:115], v247 offset:38912
    v_max_f32_dpp v88, v88, v88 row_bcast:31 row_mask:0xc bank_mask:0xf
    v_mfma_f32_16x16x32_bf16 v[124:127], v[44:47], a[140:143], v[124:127]
    ds_read_b128 v[60:63], v247 offset:39936
    v_readlane_b32 s85, v88, 63
    v_mfma_f32_16x16x32_bf16 v[28:31], v[20:23], v[80:83], 0
    ds_read_b128 v[4:7], v247 offset:40960
    v_subrev_f32 v91, s85, v91
    v_mfma_f32_16x16x32_bf16 v[108:111], v[76:79], v[80:83], 0
    ds_read_b128 v[72:75], v247 offset:41984
    v_exp_f32 v91, v91
    v_mfma_f32_16x16x32_bf16 v[120:123], v[24:27], v[80:83], 0
    ds_read_b128 v[36:39], v247 offset:43008
    v_cvt_pk_bf16_f32 v138, v124, v125
    v_mfma_f32_16x16x32_bf16 v[32:35], v[204:207], v[80:83], 0
    v_cvt_pk_bf16_f32 v139, v126, v127
    v_add_f32_dpp v88, v91, v91 row_ror:8 row_mask:0xf bank_mask:0xf
    v_mfma_f32_16x16x16_bf16 v[28:31], v[168:169], v[58:59], v[28:31]
    s_waitcnt lgkmcnt(5)
    v_add_f32_dpp v88, v88, v88 row_ror:4 row_mask:0xf bank_mask:0xf
    v_mfma_f32_16x16x16_bf16 v[108:111], v[170:171], v[58:59], v[108:111]
    s_waitcnt lgkmcnt(4)
    v_add_f32_dpp v88, v88, v88 row_ror:2 row_mask:0xf bank_mask:0xf
    v_mfma_f32_16x16x16_bf16 v[120:123], v[56:57], v[58:59], v[120:123]
    s_waitcnt lgkmcnt(3)
    v_add_f32_dpp v88, v88, v88 row_ror:1 row_mask:0xf bank_mask:0xf
    v_mfma_f32_16x16x16_bf16 v[32:35], v[208:209], v[58:59], v[32:35]
    s_waitcnt lgkmcnt(2)
    v_add_f32_dpp v88, v88, v88 row_bcast:15 row_mask:0xa bank_mask:0xf
    v_mfma_f32_16x16x32_bf16 v[80:83], a[144:147], v[140:143], 0
    s_waitcnt lgkmcnt(1)
    v_add_f32_dpp v88, v88, v88 row_bcast:31 row_mask:0xc bank_mask:0xf
    v_mfma_f32_16x16x32_bf16 v[80:83], a[156:159], v[112:115], v[80:83]
    s_waitcnt lgkmcnt(0)
    v_readlane_b32 s85, v88, 63
    v_max3_f32 v32, v28, v29, v35
    v_mfma_f32_16x16x32_bf16 v[80:83], a[168:171], v[60:63], v[80:83]
    v_max3_f32 v33, v30, v31, v108
    v_max3_f32 v32, v32, v109, v110
    v_mfma_f32_16x16x32_bf16 v[80:83], a[180:183], v[4:7], v[80:83]
    v_max3_f32 v33, v33, v111, v120
    v_max3_f32 v32, v32, v121, v122
    v_mfma_f32_16x16x32_bf16 v[80:83], a[192:195], v[72:75], v[80:83]
    v_max3_f32 v32, v32, v33, v123
    v_mov_b32 v33, v32
    v_mfma_f32_16x16x32_bf16 v[80:83], a[204:207], v[36:39], v[80:83]
    v_rcp_f32 v88, s85
    v_mfma_f32_16x16x32_bf16 v[124:127], a[148:151], v[140:143], 0
    v_permlane32_swap_b32 v32, v33
    v_mfma_f32_16x16x32_bf16 v[124:127], a[160:163], v[112:115], v[124:127]
    v_max_f32 v32, v32, v33
    v_mov_b32 v33, v32
    v_mfma_f32_16x16x32_bf16 v[124:127], a[172:175], v[60:63], v[124:127]
    v_mul_f32 v91, v91, v88
    v_cvt_pk_bf16_f32 v80, v80, v81
    v_mfma_f32_16x16x32_bf16 v[124:127], a[184:187], v[4:7], v[124:127]
    v_cvt_pk_bf16_f32 v81, v82, v83
    v_permlane16_swap_b32 v32, v33
    v_mfma_f32_16x16x32_bf16 v[124:127], a[196:199], v[72:75], v[124:127]
    v_max_f32 v32, v32, v33
    v_mul_f32 v32, s44, v32
    v_mfma_f32_16x16x32_bf16 v[124:127], a[208:211], v[36:39], v[124:127]
    v_fma_f32 v28, v28, s44, -v32
    v_fma_f32 v29, v29, s44, -v32
    v_mfma_f32_16x16x32_bf16 v[160:163], a[152:155], v[140:143], 0
    v_fma_f32 v30, v30, s44, -v32
    v_fma_f32 v31, v31, s44, -v32
    v_mfma_f32_16x16x32_bf16 v[160:163], a[164:167], v[112:115], v[160:163]
    v_fma_f32 v108, v108, s44, -v32
    v_fma_f32 v109, v109, s44, -v32
    v_mfma_f32_16x16x32_bf16 v[160:163], a[176:179], v[60:63], v[160:163]
    v_cvt_pk_bf16_f32 v82, v124, v125
    v_cvt_pk_bf16_f32 v83, v126, v127
    v_mfma_f32_16x16x32_bf16 v[160:163], a[188:191], v[4:7], v[160:163]
    v_fma_f32 v110, v110, s44, -v32
    v_fma_f32 v111, v111, s44, -v32
    v_mfma_f32_16x16x32_bf16 v[160:163], a[200:203], v[72:75], v[160:163]
    v_fma_f32 v120, v120, s44, -v32
    v_fma_f32 v121, v121, s44, -v32
    v_mfma_f32_16x16x32_bf16 v[160:163], a[212:215], v[36:39], v[160:163]
    v_fma_f32 v122, v122, s44, -v32
    v_fma_f32 v123, v123, s44, -v32
    v_mfma_f32_16x16x32_bf16 v[164:167], v[140:143], a[72:75], 0
    v_fma_f32 v35, v35, s44, -v32
    v_exp_f32 v28, v28
    v_mfma_f32_16x16x32_bf16 v[164:167], v[112:115], a[84:87], v[164:167]
    v_exp_f32 v29, v29
    v_mfma_f32_16x16x32_bf16 v[164:167], v[60:63], a[96:99], v[164:167]
    v_cvt_pk_bf16_f32 v58, v160, v161
    v_cvt_pk_bf16_f32 v59, v162, v163
    v_mfma_f32_16x16x32_bf16 v[164:167], v[4:7], a[108:111], v[164:167]
    v_exp_f32 v30, v30
    v_mfma_f32_16x16x32_bf16 v[164:167], v[72:75], a[120:123], v[164:167]
    v_exp_f32 v31, v31
    v_mfma_f32_16x16x32_bf16 v[164:167], v[36:39], a[132:135], v[164:167]
    v_exp_f32 v108, v108
    v_mfma_f32_16x16x32_bf16 v[124:127], v[140:143], a[76:79], 0
    v_cvt_pk_bf16_f32 v91, v91, v91
    v_exp_f32 v109, v109
    v_mfma_f32_16x16x32_bf16 v[124:127], v[112:115], a[88:91], v[124:127]
    ds_write_b16 v104, v91 offset:0
    v_mfma_f32_16x16x32_bf16 v[124:127], v[60:63], a[100:103], v[124:127]
    v_exp_f32 v110, v110
    v_mfma_f32_16x16x32_bf16 v[124:127], v[4:7], a[112:115], v[124:127]
    v_cvt_pk_bf16_f32 v216, v164, v165
    v_cvt_pk_bf16_f32 v217, v166, v167
    v_mfma_f32_16x16x32_bf16 v[124:127], v[72:75], a[124:127], v[124:127]
    v_exp_f32 v111, v111
    v_mfma_f32_16x16x32_bf16 v[124:127], v[36:39], a[136:139], v[124:127]
    v_exp_f32 v120, v120
    v_mfma_f32_16x16x32_bf16 v[88:91], v[140:143], a[80:83], 0
    v_exp_f32 v121, v121
    v_mfma_f32_16x16x32_bf16 v[88:91], v[112:115], a[92:95], v[88:91]
    ds_read_b128 v[140:143], v105 offset:0
    v_exp_f32 v122, v122
    v_mfma_f32_16x16x32_bf16 v[88:91], v[60:63], a[104:107], v[88:91]
    v_exp_f32 v123, v123
    v_mfma_f32_16x16x32_bf16 v[88:91], v[4:7], a[116:119], v[88:91]
    v_cvt_pk_bf16_f32 v220, v124, v125
    v_cvt_pk_bf16_f32 v221, v126, v127
    v_mfma_f32_16x16x32_bf16 v[88:91], v[72:75], a[128:131], v[88:91]
    v_exp_f32 v35, v35
    v_mfma_f32_16x16x32_bf16 v[88:91], v[36:39], a[140:143], v[88:91]
    v_cvt_pk_bf16_f32 v28, v28, v29
    v_cvt_pk_bf16_f32 v29, v30, v31
    v_mfma_f32_16x16x32_bf16 v[112:115], v[228:231], v[92:95], 0
    ds_read_b128 v[60:63], v105 offset:64
    v_cvt_pk_bf16_f32 v30, v108, v109
    v_mfma_f32_16x16x32_bf16 v[112:115], v[230:233], v[100:103], v[112:115]
    s_add_u32 s70, s39, 1806336
    v_cvt_pk_bf16_f32 v31, v110, v111
    v_cvt_pk_bf16_f32 v224, v88, v89
    v_mfma_f32_16x16x32_bf16 v[4:7], v[16:19], v[92:95], 0
    s_waitcnt lgkmcnt(1)
    v_cvt_pk_bf16_f32 v225, v90, v91
    v_cvt_pk_bf16_f32 v120, v120, v121
    v_mfma_f32_16x16x32_bf16 v[4:7], v[216:219], v[100:103], v[4:7]
    s_add_u32 s71, s39, 1892352
    v_cvt_pk_bf16_f32 v121, v122, v123
    v_cvt_pk_bf16_f32 v123, 0, v35
    v_mfma_f32_16x16x32_bf16 v[124:127], v[8:11], v[92:95], 0
    s_lshl_b32 s76, s36, 8
    v_mov_b32 v122, 0
    v_rcp_f32 v112, v112
    v_mfma_f32_16x16x32_bf16 v[124:127], v[220:223], v[100:103], v[124:127]
    s_mul_i32 s41, s38, 2688
    v_mul_f32 v4, v4, v112
    v_mul_f32 v5, v5, v112
    v_mfma_f32_16x16x32_bf16 v[72:75], v[136:139], v[92:95], 0
    s_add_u32 s41, s41, s43
    v_mul_f32 v6, v6, v112
    v_mul_f32 v7, v7, v112
    v_mfma_f32_16x16x32_bf16 v[72:75], v[224:227], v[100:103], v[72:75]
    s_waitcnt lgkmcnt(0)
    v_cvt_pk_bf16_f32 v4, v4, v5
    v_mul_f32 v124, v124, v112
    v_mfma_f32_16x16x32_bf16 v[100:103], v[228:231], v[28:31], 0
    s_add_u32 s41, s41, 516096
    v_mul_f32 v125, v125, v112
    v_mul_f32 v126, v126, v112
    v_mfma_f32_16x16x32_bf16 v[100:103], v[230:233], v[120:123], v[100:103]
    v_mul_f32 v127, v127, v112
    v_mul_f32 v72, v72, v112
    v_mfma_f32_16x16x32_bf16 v[52:55], v[16:19], v[28:31], 0
    v_mul_f32 v73, v73, v112
    v_mul_f32 v74, v74, v112
    v_mfma_f32_16x16x32_bf16 v[52:55], v[216:219], v[120:123], v[52:55]
    v_mul_f32 v75, v75, v112
    v_cvt_pk_bf16_f32 v5, v6, v7
    v_mfma_f32_16x16x32_bf16 v[48:51], v[8:11], v[28:31], 0
    v_rcp_f32 v100, v100
    v_mfma_f32_16x16x32_bf16 v[48:51], v[220:223], v[120:123], v[48:51]
    v_cvt_pk_bf16_f32 v6, v124, v125
    v_cvt_pk_bf16_f32 v7, v126, v127
    v_mfma_f32_16x16x32_bf16 v[112:115], v[136:139], v[28:31], 0
    ds_write_b128 v245, v[4:7] offset:44032
    v_mfma_f32_16x16x32_bf16 v[112:115], v[224:227], v[120:123], v[112:115]
    v_mul_f32 v52, v52, v100
    v_mul_f32 v53, v53, v100
    v_mfma_f32_16x16x32_bf16 v[28:31], v[16:19], v[140:143], 0
    v_mul_f32 v54, v54, v100
    v_mul_f32 v55, v55, v100
    v_mfma_f32_16x16x32_bf16 v[28:31], v[216:219], v[60:63], v[28:31]
    v_mul_f32 v48, v48, v100
    v_mul_f32 v49, v49, v100
    v_mfma_f32_16x16x32_bf16 v[4:7], v[8:11], v[140:143], 0
    v_mul_f32 v50, v50, v100
    v_mul_f32 v51, v51, v100
    v_mfma_f32_16x16x32_bf16 v[4:7], v[220:223], v[60:63], v[4:7]
    v_mul_f32 v112, v112, v100
    v_mul_f32 v113, v113, v100
    v_mfma_f32_16x16x32_bf16 v[156:159], v[136:139], v[140:143], 0
    v_mul_f32 v114, v114, v100
    v_mul_f32 v115, v115, v100
    v_mfma_f32_16x16x32_bf16 v[156:159], v[224:227], v[60:63], v[156:159]
    v_cvt_pk_bf16_f32 v52, v52, v53
    v_cvt_pk_bf16_f32 v53, v54, v55
    v_mfma_f32_16x16x32_bf16 v[152:155], v[20:23], v[80:83], 0
    v_cvt_pk_bf16_f32 v54, v48, v49
    v_cvt_pk_bf16_f32 v55, v50, v51
    v_mfma_f32_16x16x32_bf16 v[140:143], v[76:79], v[80:83], 0
    ds_write_b128 v245, v[52:55] offset:50176
    v_mfma_f32_16x16x32_bf16 v[100:103], v[24:27], v[80:83], 0
    v_cvt_pk_bf16_f32 v112, v112, v113
    v_cvt_pk_bf16_f32 v113, v114, v115
    v_mfma_f32_16x16x32_bf16 v[60:63], v[204:207], v[80:83], 0
    v_cvt_pk_bf16_f32 v72, v72, v73
    v_cvt_pk_bf16_f32 v73, v74, v75
    v_mfma_f32_16x16x16_bf16 v[152:155], v[168:169], v[58:59], v[152:155]
    ds_write_b64 v246, v[112:113] offset:50176
    v_mfma_f32_16x16x16_bf16 v[140:143], v[170:171], v[58:59], v[140:143]
    v_cvt_pk_bf16_f32 v28, v28, v29
    v_cvt_pk_bf16_f32 v29, v30, v31
    v_mfma_f32_16x16x16_bf16 v[100:103], v[56:57], v[58:59], v[100:103]
    ds_write_b64 v246, v[72:73] offset:44032
    v_mfma_f32_16x16x16_bf16 v[60:63], v[208:209], v[58:59], v[60:63]
    s_add_u32 s68, s39, 1978368
    v_cvt_pk_bf16_f32 v30, v4, v5
    v_cvt_pk_bf16_f32 v31, v6, v7
    v_mfma_f32_16x16x16_bf16 v[20:23], v[234:235], v[116:117], 0
    s_add_u32 s69, s39, 2064384
    ds_read_b128 v[24:27], v250 offset:3072
    ds_read_b64 v[80:81], v251 offset:3072
    v_mfma_f32_16x16x16_bf16 v[112:115], v[234:235], v[118:119], 0
    v_cvt_pk_bf16_f32 v156, v156, v157
    v_max3_f32 v60, v152, v153, v63
    v_mfma_f32_16x16x16_bf16 v[168:171], v[234:235], v[96:97], 0
    v_max3_f32 v61, v154, v155, v140
    v_max3_f32 v60, v60, v141, v142
    v_mfma_f32_16x16x16_bf16 v[56:59], v[234:235], v[12:13], 0
    v_max3_f32 v61, v61, v143, v100
    v_max3_f32 v60, v60, v101, v102
    v_mfma_f32_16x16x16_bf16 v[4:7], v[234:235], v[14:15], 0
    s_waitcnt lgkmcnt(2)
    s_barrier
    v_mfma_f32_16x16x16_bf16 v[116:119], v[234:235], v[98:99], 0
    v_max3_f32 v60, v60, v61, v103
    v_mov_b32 v61, v60
    ds_read_b128 v[12:15], v247 offset:44032
    ds_read_b128 v[96:99], v247 offset:45056
    ds_read_b128 v[132:135], v247 offset:46080
    ds_read_b128 v[128:131], v247 offset:47104
    v_permlane32_swap_b32 v60, v61
    v_max_f32 v60, v60, v61
    v_mov_b32 v61, v60
    v_cvt_pk_bf16_f32 v157, v158, v159
    s_mov_b64 exec, s[66:67]
    ds_write_b128 v250, v[28:31] offset:1536
    ds_write_b64 v251, v[156:157] offset:1536
    s_mov_b64 exec, -1
    s_waitcnt lgkmcnt(5)
    v_mfma_f32_16x16x32_bf16 v[20:23], a[216:219], v[12:15], v[20:23]
    s_waitcnt lgkmcnt(4)
    v_permlane16_swap_b32 v60, v61
    v_mfma_f32_16x16x32_bf16 v[20:23], a[228:231], v[96:99], v[20:23]
    s_waitcnt lgkmcnt(3)
    ds_read_b128 v[28:31], v247 offset:48128
    v_max_f32 v60, v60, v61
    v_mfma_f32_16x16x32_bf16 v[20:23], a[240:243], v[132:135], v[20:23]
    s_waitcnt lgkmcnt(3)
    v_mul_f32 v60, s44, v60
    v_fma_f32 v152, v152, s44, -v60
    v_mfma_f32_16x16x32_bf16 v[20:23], a[252:255], v[128:131], v[20:23]
    v_fma_f32 v153, v153, s44, -v60
    v_fma_f32 v154, v154, s44, -v60
    v_mfma_f32_16x16x32_bf16 v[112:115], a[220:223], v[12:15], v[112:115]
    ds_read_b128 v[156:159], v247 offset:49152
    v_fma_f32 v155, v155, s44, -v60
    v_mfma_f32_16x16x32_bf16 v[112:115], a[232:235], v[96:99], v[112:115]
    v_fma_f32 v140, v140, s44, -v60
    v_fma_f32 v141, v141, s44, -v60
    v_mfma_f32_16x16x32_bf16 v[112:115], a[244:247], v[132:135], v[112:115]
    v_fma_f32 v142, v142, s44, -v60
    v_fma_f32 v143, v143, s44, -v60
    v_mfma_f32_16x16x32_bf16 v[112:115], v[172:175], v[128:131], v[112:115]
    ds_read_b128 v[148:151], v247 offset:50176
    s_waitcnt lgkmcnt(2)
    v_mfma_f32_16x16x32_bf16 v[112:115], v[184:187], v[28:31], v[112:115]
    v_fma_f32 v100, v100, s44, -v60
    v_fma_f32 v101, v101, s44, -v60
    v_mfma_f32_16x16x32_bf16 v[168:171], a[224:227], v[12:15], v[168:171]
    v_fma_f32 v102, v102, s44, -v60
    v_fma_f32 v103, v103, s44, -v60
    v_mfma_f32_16x16x32_bf16 v[168:171], a[236:239], v[96:99], v[168:171]
    ds_read_b128 v[144:147], v247 offset:51200
    v_fma_f32 v63, v63, s44, -v60
    v_mfma_f32_16x16x32_bf16 v[168:171], a[248:251], v[132:135], v[168:171]
    s_waitcnt lgkmcnt(2)
    v_exp_f32 v152, v152
    v_mfma_f32_16x16x32_bf16 v[168:171], v[176:179], v[128:131], v[168:171]
    v_exp_f32 v153, v153
    v_mfma_f32_16x16x32_bf16 v[168:171], v[188:191], v[28:31], v[168:171]
    ds_read_b128 v[12:15], v247 offset:52224
    v_exp_f32 v154, v154
    v_mfma_f32_16x16x32_bf16 v[168:171], v[200:203], v[156:159], v[168:171]
    s_waitcnt lgkmcnt(2)
    v_exp_f32 v155, v155
    v_mfma_f32_16x16x32_bf16 v[20:23], v[180:183], v[28:31], v[20:23]
    v_exp_f32 v140, v140
    v_mfma_f32_16x16x32_bf16 v[20:23], v[192:195], v[156:159], v[20:23]
    ds_read_b128 v[96:99], v247 offset:53248
    v_exp_f32 v141, v141
    v_mfma_f32_16x16x32_bf16 v[112:115], v[196:199], v[156:159], v[112:115]
    s_waitcnt lgkmcnt(2)
    v_exp_f32 v142, v142
    v_mfma_f32_16x16x32_bf16 v[56:59], a[216:219], v[148:151], v[56:59]
    v_exp_f32 v143, v143
    v_mfma_f32_16x16x32_bf16 v[56:59], a[228:231], v[144:147], v[56:59]
    ds_read_b128 v[28:31], v247 offset:54272
    s_waitcnt lgkmcnt(2)
    v_mfma_f32_16x16x32_bf16 v[56:59], a[240:243], v[12:15], v[56:59]
    v_exp_f32 v100, v100
    v_mfma_f32_16x16x32_bf16 v[4:7], a[220:223], v[148:151], v[4:7]
    v_exp_f32 v101, v101
    v_mfma_f32_16x16x32_bf16 v[4:7], a[232:235], v[144:147], v[4:7]
    ds_read_b128 v[156:159], v247 offset:55296
    v_exp_f32 v102, v102
    v_mfma_f32_16x16x32_bf16 v[4:7], a[244:247], v[12:15], v[4:7]
    s_waitcnt lgkmcnt(2)
    v_exp_f32 v103, v103
    v_mfma_f32_16x16x32_bf16 v[4:7], v[172:175], v[96:99], v[4:7]
    s_waitcnt lgkmcnt(1)
    v_exp_f32 v63, v63
    v_mfma_f32_16x16x32_bf16 v[4:7], v[184:187], v[28:31], v[4:7]
    v_cvt_pk_bf16_f32 v152, v152, v153
    v_cvt_pk_bf16_f32 v153, v154, v155
    v_mfma_f32_16x16x32_bf16 v[116:119], a[224:227], v[148:151], v[116:119]
    v_cvt_pk_bf16_f32 v154, v140, v141
    v_cvt_pk_bf16_f32 v155, v142, v143
    v_mfma_f32_16x16x32_bf16 v[116:119], a[236:239], v[144:147], v[116:119]
    v_cvt_pk_bf16_f32 v100, v100, v101
    v_cvt_pk_bf16_f32 v101, v102, v103
    v_mfma_f32_16x16x32_bf16 v[116:119], a[248:251], v[12:15], v[116:119]
    v_cvt_pk_bf16_f32 v103, 0, v63
    v_mov_b32 v102, 0
    v_mfma_f32_16x16x32_bf16 v[116:119], v[176:179], v[96:99], v[116:119]
    s_waitcnt lgkmcnt(0)
    v_cvt_pk_bf16_f32 v20, v20, v21
    v_cvt_pk_bf16_f32 v21, v22, v23
    v_mfma_f32_16x16x32_bf16 v[116:119], v[188:191], v[28:31], v[116:119]
    ds_write_b64 v242, v[20:21] offset:0
    v_mfma_f32_16x16x32_bf16 v[116:119], v[200:203], v[156:159], v[116:119]
    v_cvt_pk_bf16_f32 v112, v112, v113
    v_cvt_pk_bf16_f32 v113, v114, v115
    v_mfma_f32_16x16x32_bf16 v[56:59], a[252:255], v[96:99], v[56:59]
    ds_write_b64 v242, v[112:113] offset:32
    v_mfma_f32_16x16x32_bf16 v[56:59], v[180:183], v[28:31], v[56:59]
    v_cvt_pk_bf16_f32 v168, v168, v169
    v_cvt_pk_bf16_f32 v169, v170, v171
    v_mfma_f32_16x16x32_bf16 v[56:59], v[192:195], v[156:159], v[56:59]
    ds_write_b64 v242, v[168:169] offset:64
    v_mfma_f32_16x16x32_bf16 v[4:7], v[196:199], v[156:159], v[4:7]
    v_cvt_pk_bf16_f32 v116, v116, v117
    v_cvt_pk_bf16_f32 v117, v118, v119
    v_mfma_f32_16x16x32_bf16 v[140:143], v[228:231], v[152:155], 0
    v_lshlrev_b32 v12, 16, v24
    v_and_b32 v13, 0xffff0000, v24
    v_mfma_f32_16x16x32_bf16 v[140:143], v[230:233], v[100:103], v[140:143]
    v_cvt_pk_bf16_f32 v56, v56, v57
    v_cvt_pk_bf16_f32 v57, v58, v59
    v_mfma_f32_16x16x32_bf16 v[60:63], v[16:19], v[152:155], 0
    ds_write_b64 v243, v[56:57] offset:0
    v_mfma_f32_16x16x32_bf16 v[60:63], v[216:219], v[100:103], v[60:63]
    v_cvt_pk_bf16_f32 v4, v4, v5
    v_cvt_pk_bf16_f32 v5, v6, v7
    v_mfma_f32_16x16x32_bf16 v[96:99], v[8:11], v[152:155], 0
    ds_write_b64 v243, v[4:5] offset:32
    v_mfma_f32_16x16x32_bf16 v[96:99], v[220:223], v[100:103], v[96:99]
    v_rcp_f32 v140, v140
    v_mfma_f32_16x16x32_bf16 v[112:115], v[136:139], v[152:155], 0
    ds_write_b64 v243, v[116:117] offset:64
    v_mfma_f32_16x16x32_bf16 v[112:115], v[224:227], v[100:103], v[112:115]
    v_mul_f32 v60, v60, v140
    v_mul_f32 v61, v61, v140
    v_mul_f32 v62, v62, v140
    v_mul_f32 v63, v63, v140
    v_mul_f32 v96, v96, v140
    v_mul_f32 v97, v97, v140
    v_mul_f32 v98, v98, v140
    v_mul_f32 v99, v99, v140
    v_cvt_pk_bf16_f32 v60, v60, v61
    v_mul_f32 v112, v112, v140
    v_mul_f32 v113, v113, v140
    v_mul_f32 v114, v114, v140
    v_mul_f32 v115, v115, v140
    v_cvt_pk_bf16_f32 v61, v62, v63
    v_cvt_pk_bf16_f32 v62, v96, v97
    v_cvt_pk_bf16_f32 v63, v98, v99
    v_cvt_pk_bf16_f32 v112, v112, v113
    v_cvt_pk_bf16_f32 v113, v114, v115
    ds_write_b128 v245, v[60:63] offset:56320
    v_subrev_u32 v28, s76, v250
    v_lshlrev_b32 v14, 16, v25
    v_subrev_u32 v30, 64512, v247
    v_and_b32 v15, 0xffff0000, v25
    v_bfe_u32 v31, v30, 4, 4
    v_lshlrev_b32 v168, 16, v26
    v_cmp_gt_u32 vcc, 4, v31
    v_and_b32 v169, 0xffff0000, v26
    v_mul_u32_u24 v31, 602112, v31
    ds_write_b64 v246, v[112:113] offset:56320
    v_lshlrev_b32 v170, 16, v27
    v_lshrrev_b32 v30, 8, v30
    v_and_b32 v171, 0xffff0000, v27
    v_lshl_add_u32 v30, v30, 3, v31
    v_lshlrev_b32 v8, 16, v80
    v_and_b32 v9, 0xffff0000, v80
    v_lshlrev_b32 v10, 16, v81
    v_and_b32 v11, 0xffff0000, v81
    v_add_u32 v30, s41, v30
    v_bfrev_b32 v31, 2
    v_cndmask_b32 v29, v31, v30, vcc
    v_lshlrev_b32 v4, 16, v84
    v_and_b32 v5, 0xffff0000, v84
    v_lshlrev_b32 v6, 16, v85
    v_and_b32 v7, 0xffff0000, v85
    v_lshlrev_b32 v24, 16, v86
    v_and_b32 v25, 0xffff0000, v86
    v_lshlrev_b32 v26, 16, v87
    v_and_b32 v27, 0xffff0000, v87
    v_lshlrev_b32 v68, 16, v0
    s_waitcnt lgkmcnt(0)
    s_barrier
    v_and_b32 v69, 0xffff0000, v0
    v_lshlrev_b32 v70, 16, v1
    v_and_b32 v71, 0xffff0000, v1
    ds_read_b128 v[64:67], v28 offset:1536
    ds_read_b128 v[0:3], v28 offset:1792
    ds_read_b128 v[40:43], v28 offset:2048
    ds_read_b128 v[44:47], v28 offset:2304
    ds_read_b128 v[160:163], v253 offset:0
    ds_read_b128 v[164:167], v253 offset:2800
    ds_read_b128 v[36:39], v253 offset:5600
    ds_read_b128 v[32:35], v253 offset:8400
    s_waitcnt lgkmcnt(7)
    v_mfma_f32_16x16x32_bf16 v[12:15], a[216:219], v[64:67], v[12:15]
    s_waitcnt lgkmcnt(6)
    v_mfma_f32_16x16x32_bf16 v[12:15], a[228:231], v[0:3], v[12:15]
    ds_read_b128 v[104:107], v28 offset:2560
    s_waitcnt lgkmcnt(6)
    v_mfma_f32_16x16x32_bf16 v[12:15], a[240:243], v[40:43], v[12:15]
    s_waitcnt lgkmcnt(5)
    v_mfma_f32_16x16x32_bf16 v[12:15], a[252:255], v[44:47], v[12:15]
    s_waitcnt lgkmcnt(4)
    buffer_store_dwordx4 v[160:163], v254, s[32:35], s70 offen nt
    v_mfma_f32_16x16x32_bf16 v[168:171], a[220:223], v[64:67], v[168:171]
    s_waitcnt lgkmcnt(3)
    ds_read_b128 v[108:111], v28 offset:2816
    s_add_u32 s70, s39, 2150400
    v_mfma_f32_16x16x32_bf16 v[168:171], a[232:235], v[0:3], v[168:171]
    s_waitcnt lgkmcnt(3)
    v_mfma_f32_16x16x32_bf16 v[168:171], a[244:247], v[40:43], v[168:171]
    s_waitcnt lgkmcnt(2)
    v_mfma_f32_16x16x32_bf16 v[168:171], v[172:175], v[44:47], v[168:171]
    s_waitcnt lgkmcnt(1)
    ds_read_b128 v[160:163], v247 offset:56320
    v_mfma_f32_16x16x32_bf16 v[168:171], v[184:187], v[104:107], v[168:171]
    v_mfma_f32_16x16x32_bf16 v[8:11], a[224:227], v[64:67], v[8:11]
    v_mfma_f32_16x16x32_bf16 v[8:11], a[236:239], v[0:3], v[8:11]
    ds_read_b128 v[64:67], v247 offset:57344
    buffer_store_dwordx4 v[164:167], v254, s[32:35], s71 offen nt
    v_mfma_f32_16x16x32_bf16 v[8:11], a[248:251], v[40:43], v[8:11]
    s_waitcnt lgkmcnt(2)
    s_add_u32 s71, s39, 2236416
    v_mfma_f32_16x16x32_bf16 v[8:11], v[176:179], v[44:47], v[8:11]
    v_mfma_f32_16x16x32_bf16 v[8:11], v[188:191], v[104:107], v[8:11]
    s_waitcnt lgkmcnt(1)
    ds_read_b128 v[0:3], v247 offset:58368
    v_mfma_f32_16x16x32_bf16 v[8:11], v[200:203], v[108:111], v[8:11]
    v_mfma_f32_16x16x32_bf16 v[12:15], v[180:183], v[104:107], v[12:15]
    v_mfma_f32_16x16x32_bf16 v[12:15], v[192:195], v[108:111], v[12:15]
    s_waitcnt lgkmcnt(1)
    ds_read_b128 v[164:167], v247 offset:59392
    v_mfma_f32_16x16x32_bf16 v[168:171], v[196:199], v[108:111], v[168:171]
    buffer_store_dwordx4 v[36:39], v254, s[32:35], s68 offen nt
    v_mfma_f32_16x16x32_bf16 v[4:7], a[216:219], v[160:163], v[4:7]
    s_add_u32 s68, s39, 2322432
    v_cvt_pk_bf16_f32 v8, v8, v9
    v_cvt_pk_bf16_f32 v9, v10, v11
    v_mfma_f32_16x16x32_bf16 v[4:7], a[228:231], v[64:67], v[4:7]
    s_waitcnt lgkmcnt(1)
    ds_read_b128 v[36:39], v247 offset:60416
    v_cvt_pk_bf16_f32 v12, v12, v13
    v_mfma_f32_16x16x32_bf16 v[4:7], a[240:243], v[0:3], v[4:7]
    v_cvt_pk_bf16_f32 v13, v14, v15
    v_cvt_pk_bf16_f32 v168, v168, v169
    v_mfma_f32_16x16x32_bf16 v[24:27], a[220:223], v[160:163], v[24:27]
    v_cvt_pk_bf16_f32 v169, v170, v171
    v_mfma_f32_16x16x32_bf16 v[24:27], a[232:235], v[64:67], v[24:27]
    s_waitcnt lgkmcnt(1)
    ds_read_b128 v[88:91], v247 offset:61440
    v_mfma_f32_16x16x32_bf16 v[24:27], a[244:247], v[0:3], v[24:27]
    v_mfma_f32_16x16x32_bf16 v[24:27], v[172:175], v[164:167], v[24:27]
    buffer_store_dwordx4 v[32:35], v254, s[32:35], s69 offen nt
    s_waitcnt lgkmcnt(1)
    v_mfma_f32_16x16x32_bf16 v[24:27], v[184:187], v[36:39], v[24:27]
    v_mfma_f32_16x16x32_bf16 v[68:71], a[224:227], v[160:163], v[68:71]
    v_mfma_f32_16x16x32_bf16 v[68:71], a[236:239], v[64:67], v[68:71]
    v_mfma_f32_16x16x32_bf16 v[68:71], a[248:251], v[0:3], v[68:71]
    s_waitcnt lgkmcnt(0)
    v_mfma_f32_16x16x32_bf16 v[68:71], v[176:179], v[164:167], v[68:71]
    v_mfma_f32_16x16x32_bf16 v[68:71], v[188:191], v[36:39], v[68:71]
    v_mfma_f32_16x16x32_bf16 v[68:71], v[200:203], v[88:91], v[68:71]
    buffer_store_dwordx2 v[12:13], v29, s[32:35], s39 offen nt
    v_mfma_f32_16x16x32_bf16 v[4:7], a[252:255], v[164:167], v[4:7]
    v_mfma_f32_16x16x32_bf16 v[4:7], v[180:183], v[36:39], v[4:7]
    v_mfma_f32_16x16x32_bf16 v[4:7], v[192:195], v[88:91], v[4:7]
    v_mfma_f32_16x16x32_bf16 v[24:27], v[196:199], v[88:91], v[24:27]
    s_nop 2
    v_cvt_pk_bf16_f32 v68, v68, v69
    v_cvt_pk_bf16_f32 v69, v70, v71
    s_nop 1
    v_cvt_pk_bf16_f32 v4, v4, v5
    v_cvt_pk_bf16_f32 v5, v6, v7
    ds_write_b64 v244, v[4:5] offset:0
    buffer_store_dwordx2 v[168:169], v29, s[32:35], s39 offen offset:32 nt
    v_cvt_pk_bf16_f32 v24, v24, v25
    v_cvt_pk_bf16_f32 v25, v26, v27
    ds_write_b64 v244, v[24:25] offset:32
    ds_write_b64 v244, v[68:69] offset:64
    buffer_store_dwordx2 v[8:9], v29, s[32:35], s39 offen offset:64 nt
    s_waitcnt lgkmcnt(0)
    s_barrier
    ds_read_b128 v[168:171], v253 offset:16800
    ds_read_b128 v[92:95], v253 offset:11200
    ds_read_b128 v[88:91], v253 offset:14000
    s_waitcnt lgkmcnt(1)
    buffer_store_dwordx4 v[92:95], v254, s[32:35], s70 offen nt
    s_waitcnt lgkmcnt(0)
    buffer_store_dwordx4 v[88:91], v254, s[32:35], s71 offen nt
    s_mov_b64 exec, s[48:49]
    buffer_store_dwordx4 v[168:171], v254, s[32:35], s68 offen nt
    s_mov_b64 exec, -1
L_end:
    s_endpgm

.section .rodata,"a"
.p2align 6
.amdhsa_kernel standalone__window_attn_davit__vision_kernel
  .amdhsa_next_free_vgpr 512
  .amdhsa_next_free_sgpr 102
  .amdhsa_accum_offset 256
  .amdhsa_group_segment_fixed_size 0
  .amdhsa_kernarg_size 56
  .amdhsa_user_sgpr_count 2
  .amdhsa_user_sgpr_kernarg_segment_ptr 1
  .amdhsa_system_sgpr_workgroup_id_x 1
.end_amdhsa_kernel
```
